```python
import torch

def _softmax(x, axis=-1):
    return torch.softmax(x, dim=axis)
def _gelu(x):
    return torch.nn.functional.gelu(x, approximate="tanh")
def _silu(x):
    return torch.nn.functional.silu(x)
def _sigmoid(x):
    return torch.sigmoid(x)
def _layernorm(x, axis=-1, eps=1e-5):
    m = x.mean(dim=axis, keepdim=True)
    v = x.var(dim=axis, keepdim=True, unbiased=False)
    return (x - m) / torch.sqrt(v + eps)
def _scatter_add(tgt, idx, src, axis=0):
    return tgt.clone().index_add_(axis, idx, src)
def _segment_sum(src, seg, n):
    out = torch.zeros((n,) + src.shape[1:], dtype=src.dtype)
    return out.index_add_(0, seg, src)
def _pad(x, pw):
    flat = tuple(v for pair in reversed(pw) for v in pair)
    return torch.nn.functional.pad(x, flat)

kernel_name = 'sequential_preLN__sliding_local_dilated__dense_activation_silu__prompt'

def setup_inputs():

    _w = (lambda a: (lambda t: t.to(torch.bfloat16) if t.is_floating_point() else t)(torch.as_tensor(a)))
    def _A_setup():
        B, S, D = 1, 2048, 512
        return {
            "x": _w((lambda *s: torch.randn(*s, dtype=torch.bfloat16) * 0.05)(B, S, D)),
            "wqkv": _w((lambda *s: torch.randn(*s, dtype=torch.bfloat16) * 0.05)(D, 3 * D)),
            "wo": _w((lambda *s: torch.randn(*s, dtype=torch.bfloat16) * 0.05)(D, D)),
        }
    _A_in = _A_setup()

    def _B_setup():
        B, S, D, F = 1, 2048, 512, 1792
        return {
            "x": _w((lambda *s: torch.randn(*s, dtype=torch.bfloat16) * 0.05)(B, S, D)),
            "w1": _w((lambda *s: torch.randn(*s, dtype=torch.bfloat16) * 0.8)(D, F) * (D ** -0.5)),
            "w2": _w((lambda *s: torch.randn(*s, dtype=torch.bfloat16) * 0.8)(F, D) * (F ** -0.5)),
        }
    _B_in = _B_setup()

    return {
        "A_x": _A_in["x"],
        "A_wqkv": _A_in["wqkv"],
        "A_wo": _A_in["wo"],
        "B_x": _B_in["x"],
        "B_w1": _B_in["w1"],
        "B_w2": _B_in["w2"],
    }

def reference(A_x, A_wqkv, A_wo, B_x, B_w1, B_w2):
    def _A_ref(x, wqkv, wo):
        B, S, D = x.shape
        H = 32; Dh = D // H
        W, dil = 8, 2
        qkv = (lambda x, *d: x.permute(*d))((x @ wqkv).reshape(B, S, 3, H, Dh), 2, 0, 3, 1, 4)
        q, k, v = qkv[0], qkv[1], qkv[2]
        scale = Dh ** -0.5
        pos = torch.arange(S)
        off = torch.arange(W) * dil
        idx = pos[:, None] - off[None, :]
        mask = idx >= 0
        idx_c = torch.where(mask, idx, 0).reshape(-1)
        kg = k[:, :, idx_c, :].reshape(B, H, S, W, Dh)
        vg = v[:, :, idx_c, :].reshape(B, H, S, W, Dh)
        logits = torch.einsum("bhsd,bhswd->bhsw", q, kg) * scale
        logits = torch.where(mask[None, None, :, :], logits, -1e9)
        attn = _softmax(logits, axis=-1)
        o = torch.einsum("bhsw,bhswd->bhsd", attn, vg)
        return (lambda x, *d: x.permute(*d))(o, 0, 2, 1, 3).reshape(B, S, D) @ wo

    def _B_ref(x, w1, w2):
        h = torch.einsum("bsd,df->bsf", x, w1)
        h = _silu(h)
        out = torch.einsum("bsf,fd->bsd", h, w2)
        return out

    x = A_x
    h = x + _A_ref(_layernorm(x, axis=-1), A_wqkv, A_wo)
    h2 = h + _B_ref(_layernorm(h, axis=-1), B_w1, B_w2)
    return h2
```

```asm
; @launch grid=(256,1,1) block=(512,1,1) lds=163840
.amdgcn_target "amdgcn-amd-amdhsa--gfx950"
.text
.globl sequential_preLN__sliding_local_dilated__dense_activation_silu__prompt_kernel
.p2align 8
.type sequential_preLN__sliding_local_dilated__dense_activation_silu__prompt_kernel,@function
sequential_preLN__sliding_local_dilated__dense_activation_silu__prompt_kernel:
    s_load_dwordx16 s[72:87], s[0:1], 0
    s_load_dwordx2 s[38:39], s[0:1], 64
    s_cmp_ge_u32 s2, 256
    s_cbranch_scc1 L_done
    v_and_b32 v1, 63, v0
    s_getpc_b64 s[46:47]
L_pc0:
    s_mov_b32 s48, L_done-L_pc0
    s_bfe_u32 s49, s2, 0x50003
    s_lshl_b32 s49, s49, 11
    v_and_b32 v4, 15, v0
    v_lshlrev_b32 v4, 7, v4
    v_add_u32 v4, s49, v4
    v_min_u32 v4, s48, v4
    v_cmp_gt_u32 vcc, 16, v0
    s_nop 1
    s_and_saveexec_b64 s[50:51], vcc
    s_cbranch_execz L_noct
    global_load_dword v30, v4, s[46:47]
L_noct:
    s_mov_b64 exec, s[50:51]
    v_and_b32 v2, 15, v0
    v_bfe_u32 v3, v0, 4, 2
    v_lshrrev_b32 v4, 6, v0
    s_nop 0
    v_readfirstlane_b32 s42, v4
    s_mov_b32 s52, 0x3f803f80
    v_lshlrev_b32 v7, 4, v1
    s_and_b32 s44, s42, 3
    s_lshr_b32 s43, s42, 2
    s_and_b32 s60, s44, 1
    s_lshr_b32 s61, s44, 1
    s_lshl_b32 s59, s44, 10
    v_mov_b32 v10, s52
    v_mov_b32 v11, s52
    v_mov_b32 v12, s52
    v_mov_b32 v13, s52
    v_lshrrev_b32 v4, 4, v1
    v_and_b32 v5, 7, v1
    v_lshrrev_b32 v6, 3, v1
    v_lshlrev_b32 v6, 10, v6
    v_lshlrev_b32 v9, 1, v4
    v_xor_b32 v9, v9, v5
    v_lshl_add_u32 v9, v9, 4, v6
    v_xor_b32 v16, v4, v5
    v_xor_b32 v17, 4, v16
    v_lshl_add_u32 v16, v16, 4, v6
    v_lshl_add_u32 v17, v17, 4, v6
    s_cmp_eq_u32 s60, 0
    s_cselect_b64 vcc, -1, 0
    v_cndmask_b32 v14, v17, v16, vcc
    v_lshrrev_b32 v4, 5, v1
    v_lshlrev_b32 v4, 1, v4
    v_and_b32 v5, 3, v1
    v_xor_b32 v4, v4, v5
    v_lshlrev_b32 v4, 4, v4
    v_lshrrev_b32 v5, 2, v1
    s_lshl_b32 s47, s44, 4
    v_add_u32 v5, s47, v5
    s_movk_i32 s46, 3072
    v_mul_lo_u32 v5, v5, s46
    v_add_u32 v15, v4, v5
    s_waitcnt lgkmcnt(0)
    s_mov_b32 s36, s86
    s_mov_b32 s37, s87
    s_cmp_lt_u32 s42, 4
    s_cbranch_scc1 L_noqt
    s_mov_b32 s12, s74
    s_mov_b32 s13, s75
    s_mov_b32 s14, 1572864
    s_mov_b32 s15, 0x20000
    s_lshr_b32 s48, s2, 3
    s_mul_i32 s49, s48, 49152
    v_and_b32 v4, 255, v0
    v_lshlrev_b32 v4, 7, v4
    buffer_load_dword v29, v4, s[12:15], s49 offen
    s_add_u32 s49, s49, 16384
    buffer_load_dword v29, v4, s[12:15], s49 offen
    s_mov_b32 s8, s72
    s_mov_b32 s9, s73
    s_mov_b32 s10, 2097152
    s_mov_b32 s11, 0x20000
    s_getreg_b32 s49, hwreg(HW_REG_XCC_ID)
    s_and_b32 s49, s49, 7
    s_lshl_b32 s49, s49, 18
    s_sub_u32 s49, s49, 16384
    s_max_i32 s49, s49, 0
    s_and_b32 s48, s48, 31
    s_mul_i32 s48, s48, 8704
    s_add_u32 s49, s49, s48
    v_and_b32 v4, 255, v0
    v_min_u32 v4, 67, v4
    v_lshlrev_b32 v4, 7, v4
    buffer_load_dword v29, v4, s[8:11], s49 offen
L_noqt:
    s_cmp_lg_u32 s42, 0
    s_cbranch_scc1 L_tk_done
    s_getreg_b32 s46, hwreg(HW_REG_XCC_ID)
    s_and_b32 s46, s46, 7
    s_mov_b32 s48, 0
    s_memrealtime s[50:51]
    s_mov_b64 exec, 1
    v_mov_b32 v5, 1
L_tk:
    s_and_b32 s47, s46, 3
    s_lshl_b32 s47, s47, 3
    s_lshr_b32 s49, s46, 2
    s_lshl_b32 s49, s49, 7
    s_add_u32 s47, s47, s49
    v_mov_b32 v4, s47
    global_atomic_add v6, v4, v5, s[36:37] sc0 sc1
    s_waitcnt vmcnt(0) lgkmcnt(0)
    v_readfirstlane_b32 s47, v6
    s_nop 1
    s_and_b32 s47, s47, 0xffff
    s_cmp_lt_u32 s47, 32
    s_cbranch_scc1 L_tk_got
    s_add_u32 s46, s46, 1
    s_and_b32 s46, s46, 7
    s_add_u32 s48, s48, 1
    v_mov_b32 v5, 0x10001
    s_cmp_lt_u32 s48, 64
    s_cbranch_scc1 L_tk
    s_and_b32 s47, s47, 31
L_tk_got:
    s_cmp_lg_u32 s47, 0
    s_cbranch_scc1 L_tk_nn
    s_or_b32 s50, s50, 1
    v_mov_b32 v5, s50
    global_store_dword v4, v5, s[36:37] offset:4 sc1
L_tk_nn:
    s_mov_b32 s48, 0
    s_lshl_b32 s47, s47, 8
    s_or_b32 s46, s46, s47
    s_lshl_b32 s47, s48, 16
    s_or_b32 s46, s46, s47
    v_mov_b32 v4, s46
    v_mov_b32 v5, 163832
    ds_write_b32 v5, v4
    s_mov_b64 exec, -1
    s_waitcnt lgkmcnt(0)
L_tk_done:
    s_barrier
    v_mov_b32 v5, 163832
    ds_read_b32 v4, v5
    s_waitcnt lgkmcnt(0)
    v_readfirstlane_b32 s46, v4
    s_nop 1
    s_and_b32 s100, s46, 7
    s_bfe_u32 s4, s46, 0x50008
    s_lshr_b32 s7, s46, 16
    s_lshl_b32 s46, s100, 1
    s_and_b32 s47, s4, 1
    s_add_u32 s40, s46, s47
    s_lshr_b32 s41, s4, 1
    s_lshr_b32 s45, s41, 1
    s_and_b32 s47, s41, 1
    s_lshl_b32 s47, s47, 2
    s_add_u32 s45, s45, s47
    s_and_b32 s45, s45, 7
    s_mov_b32 s5, s41
    s_mov_b32 s3, s40
    s_mov_b32 s49, s41
    s_and_b32 s56, s49, 7
    s_lshr_b32 s57, s49, 3
    s_mul_i32 s6, s56, 7
    s_lshr_b32 s6, s6, 2
    s_lshl_b32 s50, s40, 8
    s_lshl_b32 s47, s41, 2
    s_add_u32 s50, s50, s47
    s_mov_b32 s47, 0
    s_add_u32 s50, s50, 13631488
    s_lshl_b32 s51, s3, 8
    s_lshl_b32 s46, s49, 2
    s_add_u32 s51, s51, s46
    s_add_u32 s51, s51, s47
    s_add_u32 s51, s51, 13631488
    s_mov_b32 s69, s51
    s_cmp_eq_u32 s43, 0
    s_cselect_b32 s46, s50, s51
    v_mov_b32 v8, s46
    s_lshl_b32 s53, s40, 17
    s_lshl_b32 s46, s44, 13
    s_add_u32 s53, s53, s46
    s_lshl_b32 s54, s40, 17
    s_sub_u32 s54, s54, 16384
    s_max_i32 s54, s54, 0
    s_lshl_b32 s55, s41, 6
    s_mov_b32 s8, s72
    s_mov_b32 s9, s73
    s_mov_b32 s10, 2097152
    s_mov_b32 s11, 0x20000
    s_mov_b32 s12, s74
    s_mov_b32 s13, s75
    s_mov_b32 s14, 1572864
    s_mov_b32 s15, 0x20000
    s_cmp_eq_u32 s43, 0
    s_cbranch_scc0 L_teamB
    s_add_u32 s66, s45, 0
    s_and_b32 s66, s66, 7
    s_lshl_b32 s65, s66, 7
    s_add_u32 s65, s65, s53
    s_mul_i32 s66, s66, 196608
    s_add_u32 s66, s66, s55
    s_add_u32 m0, s59, 36864
    s_add_u32 s64, s66, 1024
    buffer_load_dwordx4 v15, s[12:15], s64 offen lds
    s_add_u32 m0, s59, 40960
    s_add_u32 s64, s66, 2048
    buffer_load_dwordx4 v15, s[12:15], s64 offen lds
    s_add_u32 m0, s59, 32768
    s_add_u32 s64, s66, 0
    buffer_load_dwordx4 v15, s[12:15], s64 offen lds
    s_add_u32 m0, s59, 16384
    s_add_u32 s64, s65, 0
    buffer_load_dwordx4 v14, s[8:11], s64 offen lds
    s_add_u32 m0, s59, 20480
    s_add_u32 s64, s65, 32768
    buffer_load_dwordx4 v14, s[8:11], s64 offen lds
    s_add_u32 m0, s59, 24576
    s_add_u32 s64, s65, 65536
    buffer_load_dwordx4 v14, s[8:11], s64 offen lds
    s_add_u32 m0, s59, 28672
    s_add_u32 s64, s65, 98304
    buffer_load_dwordx4 v14, s[8:11], s64 offen lds
    s_lshl_b32 s46, s44, 1
    s_add_u32 s46, s46, 0
    s_add_u32 s47, s46, s45
    s_and_b32 s47, s47, 7
    s_lshl_b32 s47, s47, 7
    s_add_u32 s47, s47, s54
    s_lshl_b32 s46, s46, 11
    s_add_u32 m0, s46, 0
    s_add_u32 s64, s47, 0
    buffer_load_dwordx4 v16, s[8:11], s64 offen lds
    s_add_u32 m0, s46, 1024
    s_add_u32 s64, s47, 8192
    buffer_load_dwordx4 v17, s[8:11], s64 offen lds
    s_lshl_b32 s46, s44, 1
    s_add_u32 s46, s46, 1
    s_add_u32 s47, s46, s45
    s_and_b32 s47, s47, 7
    s_lshl_b32 s47, s47, 7
    s_add_u32 s47, s47, s54
    s_lshl_b32 s46, s46, 11
    s_add_u32 m0, s46, 0
    s_add_u32 s64, s47, 0
    buffer_load_dwordx4 v16, s[8:11], s64 offen lds
    s_add_u32 m0, s46, 1024
    s_add_u32 s64, s47, 8192
    buffer_load_dwordx4 v17, s[8:11], s64 offen lds
    s_mov_b32 s32, s38
    s_mov_b32 s33, s39
    s_mov_b32 s34, 16777216
    s_mov_b32 s35, 0x20000
    s_mov_b32 s16, s76
    s_mov_b32 s17, s77
    s_mov_b32 s18, 524288
    s_mov_b32 s19, 0x20000
    s_mov_b32 s20, s80
    s_mov_b32 s21, s81
    s_mov_b32 s22, 1835008
    s_mov_b32 s23, 0x20000
    s_mov_b32 s24, s82
    s_mov_b32 s25, s83
    s_mov_b32 s26, 1835008
    s_mov_b32 s27, 0x20000
    s_mov_b32 s28, s84
    s_mov_b32 s29, s85
    s_mov_b32 s30, 2097152
    s_mov_b32 s31, 0x20000
    s_and_b32 s46, s100, 3
    s_lshl_b32 s46, s46, 3
    s_lshr_b32 s47, s100, 2
    s_lshl_b32 s47, s47, 7
    s_add_u32 s46, s46, s47
    v_mov_b32 v250, s46
    v_lshrrev_b32 v4, 1, v2
    v_xor_b32 v4, v4, v3
    v_lshlrev_b32 v4, 4, v4
    v_lshl_add_u32 v16, v2, 7, v4
    v_xor_b32 v17, 64, v16
    v_lshrrev_b32 v4, 2, v2
    v_lshl_add_u32 v4, v3, 3, v4
    v_lshlrev_b32 v4, 6, v4
    v_and_b32 v5, 1, v3
    v_xor_b32 v5, s60, v5
    v_lshl_add_u32 v4, v5, 5, v4
    v_and_b32 v5, 3, v1
    v_lshl_add_u32 v18, v5, 3, v4
    s_mov_b32 s49, 0x80000001
    s_mov_b32 s50, 0x80000000
    v_mov_b32 v164, 0xf149f2ca
    s_or_b32 s46, s40, s61
    s_cmp_eq_u32 s46, 0
    s_cselect_b32 s51, -1, 0
    v_lshlrev_b32 v4, 2, v3
    v_add_u32 v4, 0, v4
    v_sub_u32 v4, v2, v4
    v_and_b32 v4, s49, v4
    v_cmp_eq_u32 vcc, 0, v4
    s_nop 1
    v_cndmask_b32 v152, v164, 0, vcc
    v_cmp_eq_u32 vcc, s50, v4
    s_nop 1
    v_cndmask_b32 v156, v164, 0, vcc
    v_and_b32 v5, s51, v164
    v_or_b32 v160, v5, v156
    v_lshlrev_b32 v4, 2, v3
    v_add_u32 v4, 1, v4
    v_sub_u32 v4, v2, v4
    v_and_b32 v4, s49, v4
    v_cmp_eq_u32 vcc, 0, v4
    s_nop 1
    v_cndmask_b32 v153, v164, 0, vcc
    v_cmp_eq_u32 vcc, s50, v4
    s_nop 1
    v_cndmask_b32 v157, v164, 0, vcc
    v_and_b32 v5, s51, v164
    v_or_b32 v161, v5, v157
    v_lshlrev_b32 v4, 2, v3
    v_add_u32 v4, 2, v4
    v_sub_u32 v4, v2, v4
    v_and_b32 v4, s49, v4
    v_cmp_eq_u32 vcc, 0, v4
    s_nop 1
    v_cndmask_b32 v154, v164, 0, vcc
    v_cmp_eq_u32 vcc, s50, v4
    s_nop 1
    v_cndmask_b32 v158, v164, 0, vcc
    v_and_b32 v5, s51, v164
    v_or_b32 v162, v5, v158
    v_lshlrev_b32 v4, 2, v3
    v_add_u32 v4, 3, v4
    v_sub_u32 v4, v2, v4
    v_and_b32 v4, s49, v4
    v_cmp_eq_u32 vcc, 0, v4
    s_nop 1
    v_cndmask_b32 v155, v164, 0, vcc
    v_cmp_eq_u32 vcc, s50, v4
    s_nop 1
    v_cndmask_b32 v159, v164, 0, vcc
    v_and_b32 v5, s51, v164
    v_or_b32 v163, v5, v159
    s_movk_i32 s46, 4682
    s_movk_i32 s47, 3584
    v_add_u32 v4, 0, v1
    v_mul_lo_u32 v5, v4, s46
    v_lshrrev_b32 v5, 16, v5
    v_mul_u32_u24 v24, 14, v5
    v_sub_u32 v24, v4, v24
    v_mul_lo_u32 v5, v5, s47
    v_lshl_add_u32 v24, v24, 4, v5
    v_add_u32 v4, 64, v1
    v_mul_lo_u32 v5, v4, s46
    v_lshrrev_b32 v5, 16, v5
    v_mul_u32_u24 v25, 14, v5
    v_sub_u32 v25, v4, v25
    v_mul_lo_u32 v5, v5, s47
    v_lshl_add_u32 v25, v25, 4, v5
    v_add_u32 v4, 128, v1
    v_mul_lo_u32 v5, v4, s46
    v_lshrrev_b32 v5, 16, v5
    v_mul_u32_u24 v26, 14, v5
    v_sub_u32 v26, v4, v26
    v_mul_lo_u32 v5, v5, s47
    v_lshl_add_u32 v26, v26, 4, v5
    v_add_u32 v4, 192, v1
    v_mul_lo_u32 v5, v4, s46
    v_lshrrev_b32 v5, 16, v5
    v_mul_u32_u24 v27, 14, v5
    v_sub_u32 v27, v4, v27
    v_mul_lo_u32 v5, v5, s47
    v_lshl_add_u32 v27, v27, 4, v5
    v_add_u32 v4, 256, v1
    v_mul_lo_u32 v5, v4, s46
    v_lshrrev_b32 v5, 16, v5
    v_mul_u32_u24 v28, 14, v5
    v_sub_u32 v28, v4, v28
    v_mul_lo_u32 v5, v5, s47
    v_lshl_add_u32 v28, v28, 4, v5
    v_add_u32 v4, 320, v1
    v_mul_lo_u32 v5, v4, s46
    v_lshrrev_b32 v5, 16, v5
    v_mul_u32_u24 v29, 14, v5
    v_sub_u32 v29, v4, v29
    v_mul_lo_u32 v5, v5, s47
    v_lshl_add_u32 v29, v29, 4, v5
    v_add_u32 v4, 384, v1
    v_mul_lo_u32 v5, v4, s46
    v_lshrrev_b32 v5, 16, v5
    v_mul_u32_u24 v30, 14, v5
    v_sub_u32 v30, v4, v30
    v_mul_lo_u32 v5, v5, s47
    v_lshl_add_u32 v30, v30, 4, v5
    s_mul_i32 s67, s41, 224
    s_mul_i32 s68, s44, 7168
    v_mov_b32 v4, 0
    v_mov_b32 v5, 162304
    ds_write_b32 v5, v4
    s_waitcnt lgkmcnt(0)
    s_waitcnt vmcnt(0)
    s_barrier
    s_lshl_b32 s46, s61, 13
    s_add_u32 s46, s46, 14336
    s_cmp_eq_u32 s61, 0
    s_cselect_b32 s47, 0, s46
    v_add_u32 v19, s46, v16
    v_add_u32 v20, s46, v17
    v_add_u32 v21, s47, v16
    v_add_u32 v22, s47, v17
    v_add_u32 v23, 32768, v18
    ds_read_b64_tr_b16 v[36:37], v23 offset:4096
    ds_read_b64_tr_b16 v[38:39], v23 offset:4352
    ds_read_b64_tr_b16 v[40:41], v23 offset:8192
    ds_read_b64_tr_b16 v[42:43], v23 offset:8448
    ds_read_b64_tr_b16 v[32:33], v23 offset:0
    ds_read_b64_tr_b16 v[34:35], v23 offset:256
    ds_read_b128 v[56:59], v21
    ds_read_b128 v[60:63], v19 offset:2048
    ds_read_b128 v[64:67], v19 offset:4096
    ds_read_b128 v[68:71], v19 offset:6144
    ds_read_b128 v[72:75], v19 offset:8192
    s_waitcnt lgkmcnt(0)
    v_mfma_f32_16x16x32_bf16 v[112:115], v[36:39], v[56:59], 0
    ds_read_b64_tr_b16 v[48:49], v23 offset:6144
    v_mfma_f32_16x16x32_bf16 v[132:135], v[56:59], v[40:43], 0
    ds_read_b64_tr_b16 v[50:51], v23 offset:6400
    v_mfma_f32_16x16x32_bf16 v[116:119], v[36:39], v[60:63], 0
    ds_read_b64_tr_b16 v[52:53], v23 offset:10240
    v_mfma_f32_16x16x32_bf16 v[136:139], v[60:63], v[40:43], 0
    ds_read_b64_tr_b16 v[54:55], v23 offset:10496
    v_mfma_f32_16x16x32_bf16 v[96:99], v[32:35], v[60:63], 0
    v_mfma_f32_16x16x32_bf16 v[120:123], v[36:39], v[64:67], 0
    ds_read_b64_tr_b16 v[44:45], v23 offset:2048
    v_mfma_f32_16x16x32_bf16 v[140:143], v[64:67], v[40:43], 0
    ds_read_b64_tr_b16 v[46:47], v23 offset:2304
    v_mfma_f32_16x16x32_bf16 v[100:103], v[32:35], v[64:67], 0
    ds_read_b128 v[76:79], v22
    v_mfma_f32_16x16x32_bf16 v[124:127], v[36:39], v[68:71], 0
    ds_read_b128 v[80:83], v20 offset:2048
    v_mfma_f32_16x16x32_bf16 v[144:147], v[68:71], v[40:43], 0
    v_mfma_f32_16x16x32_bf16 v[104:107], v[32:35], v[68:71], 0
    ds_read_b128 v[84:87], v20 offset:4096
    v_mfma_f32_16x16x32_bf16 v[128:131], v[36:39], v[72:75], 0
    ds_read_b128 v[88:91], v20 offset:6144
    v_mfma_f32_16x16x32_bf16 v[148:151], v[72:75], v[40:43], 0
    ds_read_b128 v[92:95], v20 offset:8192
    v_mfma_f32_16x16x32_bf16 v[108:111], v[32:35], v[72:75], 0
    s_waitcnt lgkmcnt(0)
    s_barrier
    s_cmp_lg_u32 s42, 0
    s_cbranch_scc1 L_nomode0
    s_mov_b64 exec, 1
    global_load_dwordx2 v[252:253], v250, s[36:37] sc1
    s_mov_b64 exec, -1
L_nomode0:
    s_lshl_b32 s46, s61, 13
    s_add_u32 s46, s46, 43008
    s_cmp_eq_u32 s61, 0
    s_cselect_b32 s47, 2048, s46
    v_add_u32 v19, s46, v16
    v_add_u32 v20, s46, v17
    v_add_u32 v21, s47, v16
    v_add_u32 v22, s47, v17
    v_add_u32 v23, 61440, v18
    v_mfma_f32_16x16x32_bf16 v[112:115], v[48:51], v[76:79], v[112:115]
    ds_read_b64_tr_b16 v[36:37], v23 offset:4096
    v_mfma_f32_16x16x32_bf16 v[132:135], v[76:79], v[52:55], v[132:135]
    ds_read_b64_tr_b16 v[38:39], v23 offset:4352
    v_mfma_f32_16x16x32_bf16 v[116:119], v[48:51], v[80:83], v[116:119]
    ds_read_b64_tr_b16 v[40:41], v23 offset:8192
    v_mfma_f32_16x16x32_bf16 v[136:139], v[80:83], v[52:55], v[136:139]
    ds_read_b64_tr_b16 v[42:43], v23 offset:8448
    v_mfma_f32_16x16x32_bf16 v[96:99], v[44:47], v[80:83], v[96:99]
    v_mfma_f32_16x16x32_bf16 v[120:123], v[48:51], v[84:87], v[120:123]
    ds_read_b64_tr_b16 v[32:33], v23 offset:0
    v_mfma_f32_16x16x32_bf16 v[140:143], v[84:87], v[52:55], v[140:143]
    ds_read_b64_tr_b16 v[34:35], v23 offset:256
    v_mfma_f32_16x16x32_bf16 v[100:103], v[44:47], v[84:87], v[100:103]
    ds_read_b128 v[56:59], v21
    v_mfma_f32_16x16x32_bf16 v[124:127], v[48:51], v[88:91], v[124:127]
    ds_read_b128 v[60:63], v19 offset:2048
    v_mfma_f32_16x16x32_bf16 v[144:147], v[88:91], v[52:55], v[144:147]
    v_mfma_f32_16x16x32_bf16 v[104:107], v[44:47], v[88:91], v[104:107]
    ds_read_b128 v[64:67], v19 offset:4096
    v_mfma_f32_16x16x32_bf16 v[128:131], v[48:51], v[92:95], v[128:131]
    ds_read_b128 v[68:71], v19 offset:6144
    v_mfma_f32_16x16x32_bf16 v[148:151], v[92:95], v[52:55], v[148:151]
    ds_read_b128 v[72:75], v19 offset:8192
    v_mfma_f32_16x16x32_bf16 v[108:111], v[44:47], v[92:95], v[108:111]
    s_waitcnt lgkmcnt(0)
    v_mfma_f32_16x16x32_bf16 v[112:115], v[36:39], v[56:59], v[112:115]
    ds_read_b64_tr_b16 v[48:49], v23 offset:6144
    v_mfma_f32_16x16x32_bf16 v[132:135], v[56:59], v[40:43], v[132:135]
    ds_read_b64_tr_b16 v[50:51], v23 offset:6400
    v_mfma_f32_16x16x32_bf16 v[116:119], v[36:39], v[60:63], v[116:119]
    ds_read_b64_tr_b16 v[52:53], v23 offset:10240
    v_mfma_f32_16x16x32_bf16 v[136:139], v[60:63], v[40:43], v[136:139]
    ds_read_b64_tr_b16 v[54:55], v23 offset:10496
    v_mfma_f32_16x16x32_bf16 v[96:99], v[32:35], v[60:63], v[96:99]
    v_mfma_f32_16x16x32_bf16 v[120:123], v[36:39], v[64:67], v[120:123]
    ds_read_b64_tr_b16 v[44:45], v23 offset:2048
    v_mfma_f32_16x16x32_bf16 v[140:143], v[64:67], v[40:43], v[140:143]
    ds_read_b64_tr_b16 v[46:47], v23 offset:2304
    v_mfma_f32_16x16x32_bf16 v[100:103], v[32:35], v[64:67], v[100:103]
    ds_read_b128 v[76:79], v22
    v_mfma_f32_16x16x32_bf16 v[124:127], v[36:39], v[68:71], v[124:127]
    ds_read_b128 v[80:83], v20 offset:2048
    v_mfma_f32_16x16x32_bf16 v[144:147], v[68:71], v[40:43], v[144:147]
    v_mfma_f32_16x16x32_bf16 v[104:107], v[32:35], v[68:71], v[104:107]
    ds_read_b128 v[84:87], v20 offset:4096
    v_mfma_f32_16x16x32_bf16 v[128:131], v[36:39], v[72:75], v[128:131]
    ds_read_b128 v[88:91], v20 offset:6144
    v_mfma_f32_16x16x32_bf16 v[148:151], v[72:75], v[40:43], v[148:151]
    ds_read_b128 v[92:95], v20 offset:8192
    v_mfma_f32_16x16x32_bf16 v[108:111], v[32:35], v[72:75], v[108:111]
    s_waitcnt lgkmcnt(0)
    s_barrier
    s_lshl_b32 s46, s61, 13
    s_add_u32 s46, s46, 71680
    s_cmp_eq_u32 s61, 0
    s_cselect_b32 s47, 4096, s46
    v_add_u32 v19, s46, v16
    v_add_u32 v20, s46, v17
    v_add_u32 v21, s47, v16
    v_add_u32 v22, s47, v17
    v_add_u32 v23, 90112, v18
    v_mfma_f32_16x16x32_bf16 v[112:115], v[48:51], v[76:79], v[112:115]
    ds_read_b64_tr_b16 v[36:37], v23 offset:4096
    v_mfma_f32_16x16x32_bf16 v[132:135], v[76:79], v[52:55], v[132:135]
    ds_read_b64_tr_b16 v[38:39], v23 offset:4352
    v_mfma_f32_16x16x32_bf16 v[116:119], v[48:51], v[80:83], v[116:119]
    ds_read_b64_tr_b16 v[40:41], v23 offset:8192
    v_mfma_f32_16x16x32_bf16 v[136:139], v[80:83], v[52:55], v[136:139]
    ds_read_b64_tr_b16 v[42:43], v23 offset:8448
    v_mfma_f32_16x16x32_bf16 v[96:99], v[44:47], v[80:83], v[96:99]
    v_mfma_f32_16x16x32_bf16 v[120:123], v[48:51], v[84:87], v[120:123]
    ds_read_b64_tr_b16 v[32:33], v23 offset:0
    v_mfma_f32_16x16x32_bf16 v[140:143], v[84:87], v[52:55], v[140:143]
    ds_read_b64_tr_b16 v[34:35], v23 offset:256
    v_mfma_f32_16x16x32_bf16 v[100:103], v[44:47], v[84:87], v[100:103]
    ds_read_b128 v[56:59], v21
    v_mfma_f32_16x16x32_bf16 v[124:127], v[48:51], v[88:91], v[124:127]
    ds_read_b128 v[60:63], v19 offset:2048
    v_mfma_f32_16x16x32_bf16 v[144:147], v[88:91], v[52:55], v[144:147]
    v_mfma_f32_16x16x32_bf16 v[104:107], v[44:47], v[88:91], v[104:107]
    ds_read_b128 v[64:67], v19 offset:4096
    v_mfma_f32_16x16x32_bf16 v[128:131], v[48:51], v[92:95], v[128:131]
    ds_read_b128 v[68:71], v19 offset:6144
    v_mfma_f32_16x16x32_bf16 v[148:151], v[92:95], v[52:55], v[148:151]
    ds_read_b128 v[72:75], v19 offset:8192
    v_mfma_f32_16x16x32_bf16 v[108:111], v[44:47], v[92:95], v[108:111]
    s_waitcnt lgkmcnt(0)
    v_mfma_f32_16x16x32_bf16 v[112:115], v[36:39], v[56:59], v[112:115]
    ds_read_b64_tr_b16 v[48:49], v23 offset:6144
    v_mfma_f32_16x16x32_bf16 v[132:135], v[56:59], v[40:43], v[132:135]
    ds_read_b64_tr_b16 v[50:51], v23 offset:6400
    v_mfma_f32_16x16x32_bf16 v[116:119], v[36:39], v[60:63], v[116:119]
    ds_read_b64_tr_b16 v[52:53], v23 offset:10240
    v_mfma_f32_16x16x32_bf16 v[136:139], v[60:63], v[40:43], v[136:139]
    ds_read_b64_tr_b16 v[54:55], v23 offset:10496
    v_mfma_f32_16x16x32_bf16 v[96:99], v[32:35], v[60:63], v[96:99]
    v_mfma_f32_16x16x32_bf16 v[120:123], v[36:39], v[64:67], v[120:123]
    ds_read_b64_tr_b16 v[44:45], v23 offset:2048
    v_mfma_f32_16x16x32_bf16 v[140:143], v[64:67], v[40:43], v[140:143]
    ds_read_b64_tr_b16 v[46:47], v23 offset:2304
    v_mfma_f32_16x16x32_bf16 v[100:103], v[32:35], v[64:67], v[100:103]
    ds_read_b128 v[76:79], v22
    v_mfma_f32_16x16x32_bf16 v[124:127], v[36:39], v[68:71], v[124:127]
    ds_read_b128 v[80:83], v20 offset:2048
    v_mfma_f32_16x16x32_bf16 v[144:147], v[68:71], v[40:43], v[144:147]
    v_mfma_f32_16x16x32_bf16 v[104:107], v[32:35], v[68:71], v[104:107]
    ds_read_b128 v[84:87], v20 offset:4096
    v_mfma_f32_16x16x32_bf16 v[128:131], v[36:39], v[72:75], v[128:131]
    ds_read_b128 v[88:91], v20 offset:6144
    v_mfma_f32_16x16x32_bf16 v[148:151], v[72:75], v[40:43], v[148:151]
    ds_read_b128 v[92:95], v20 offset:8192
    v_mfma_f32_16x16x32_bf16 v[108:111], v[32:35], v[72:75], v[108:111]
    s_waitcnt lgkmcnt(0)
    s_barrier
    s_cmp_lg_u32 s42, 0
    s_cbranch_scc1 L_nomode
    s_mov_b32 s58, 0
    s_mov_b64 exec, 1
L_mode:
    s_waitcnt vmcnt(0)
    v_readfirstlane_b32 s47, v252
    v_readfirstlane_b32 s48, v253
    s_add_u32 s58, s58, 1
    s_and_b32 s46, s47, 0xffff
    s_cmp_ge_u32 s46, 32
    s_cselect_b32 s46, s48, 0
    s_cmp_lg_u32 s46, 0
    s_cbranch_scc1 L_mode_ok
    s_sleep 4
    global_load_dwordx2 v[252:253], v250, s[36:37] sc1
    s_cmp_lt_u32 s58, 0x8000
    s_cbranch_scc1 L_mode
L_mode_ok:
    s_lshr_b32 s47, s47, 16
    s_cmp_eq_u32 s47, 0
    s_cselect_b32 s47, 1, 0
    v_mov_b32 v252, s47
    v_mov_b32 v253, s48
    v_mov_b32 v4, 163816
    ds_write_b64 v4, v[252:253]
    s_mov_b64 exec, -1
    s_waitcnt lgkmcnt(0)
L_nomode:
    s_lshl_b32 s46, s61, 13
    s_add_u32 s46, s46, 100352
    s_cmp_eq_u32 s61, 0
    s_cselect_b32 s47, 6144, s46
    v_add_u32 v19, s46, v16
    v_add_u32 v20, s46, v17
    v_add_u32 v21, s47, v16
    v_add_u32 v22, s47, v17
    v_add_u32 v23, 118784, v18
    v_mfma_f32_16x16x32_bf16 v[112:115], v[48:51], v[76:79], v[112:115]
    ds_read_b64_tr_b16 v[36:37], v23 offset:4096
    v_mfma_f32_16x16x32_bf16 v[132:135], v[76:79], v[52:55], v[132:135]
    ds_read_b64_tr_b16 v[38:39], v23 offset:4352
    v_mfma_f32_16x16x32_bf16 v[116:119], v[48:51], v[80:83], v[116:119]
    ds_read_b64_tr_b16 v[40:41], v23 offset:8192
    v_mfma_f32_16x16x32_bf16 v[136:139], v[80:83], v[52:55], v[136:139]
    ds_read_b64_tr_b16 v[42:43], v23 offset:8448
    v_mfma_f32_16x16x32_bf16 v[96:99], v[44:47], v[80:83], v[96:99]
    v_mfma_f32_16x16x32_bf16 v[120:123], v[48:51], v[84:87], v[120:123]
    ds_read_b64_tr_b16 v[32:33], v23 offset:0
    v_mfma_f32_16x16x32_bf16 v[140:143], v[84:87], v[52:55], v[140:143]
    ds_read_b64_tr_b16 v[34:35], v23 offset:256
    v_mfma_f32_16x16x32_bf16 v[100:103], v[44:47], v[84:87], v[100:103]
    ds_read_b128 v[56:59], v21
    v_mfma_f32_16x16x32_bf16 v[124:127], v[48:51], v[88:91], v[124:127]
    ds_read_b128 v[60:63], v19 offset:2048
    v_mfma_f32_16x16x32_bf16 v[144:147], v[88:91], v[52:55], v[144:147]
    v_mfma_f32_16x16x32_bf16 v[104:107], v[44:47], v[88:91], v[104:107]
    ds_read_b128 v[64:67], v19 offset:4096
    v_mfma_f32_16x16x32_bf16 v[128:131], v[48:51], v[92:95], v[128:131]
    ds_read_b128 v[68:71], v19 offset:6144
    v_mfma_f32_16x16x32_bf16 v[148:151], v[92:95], v[52:55], v[148:151]
    ds_read_b128 v[72:75], v19 offset:8192
    v_mfma_f32_16x16x32_bf16 v[108:111], v[44:47], v[92:95], v[108:111]
    s_waitcnt lgkmcnt(0)
    v_mfma_f32_16x16x32_bf16 v[112:115], v[36:39], v[56:59], v[112:115]
    ds_read_b64_tr_b16 v[48:49], v23 offset:6144
    v_mfma_f32_16x16x32_bf16 v[132:135], v[56:59], v[40:43], v[132:135]
    ds_read_b64_tr_b16 v[50:51], v23 offset:6400
    v_mfma_f32_16x16x32_bf16 v[116:119], v[36:39], v[60:63], v[116:119]
    ds_read_b64_tr_b16 v[52:53], v23 offset:10240
    v_mfma_f32_16x16x32_bf16 v[136:139], v[60:63], v[40:43], v[136:139]
    ds_read_b64_tr_b16 v[54:55], v23 offset:10496
    v_mfma_f32_16x16x32_bf16 v[96:99], v[32:35], v[60:63], v[96:99]
    v_mfma_f32_16x16x32_bf16 v[120:123], v[36:39], v[64:67], v[120:123]
    ds_read_b64_tr_b16 v[44:45], v23 offset:2048
    v_mfma_f32_16x16x32_bf16 v[140:143], v[64:67], v[40:43], v[140:143]
    ds_read_b64_tr_b16 v[46:47], v23 offset:2304
    v_mfma_f32_16x16x32_bf16 v[100:103], v[32:35], v[64:67], v[100:103]
    ds_read_b128 v[76:79], v22
    v_mfma_f32_16x16x32_bf16 v[124:127], v[36:39], v[68:71], v[124:127]
    ds_read_b128 v[80:83], v20 offset:2048
    v_mfma_f32_16x16x32_bf16 v[144:147], v[68:71], v[40:43], v[144:147]
    v_mfma_f32_16x16x32_bf16 v[104:107], v[32:35], v[68:71], v[104:107]
    ds_read_b128 v[84:87], v20 offset:4096
    v_mfma_f32_16x16x32_bf16 v[128:131], v[36:39], v[72:75], v[128:131]
    ds_read_b128 v[88:91], v20 offset:6144
    v_mfma_f32_16x16x32_bf16 v[148:151], v[72:75], v[40:43], v[148:151]
    ds_read_b128 v[92:95], v20 offset:8192
    v_mfma_f32_16x16x32_bf16 v[108:111], v[32:35], v[72:75], v[108:111]
    s_waitcnt lgkmcnt(0)
    s_barrier
    s_lshl_b32 s46, s61, 13
    s_add_u32 s46, s46, 129024
    s_cmp_eq_u32 s61, 0
    s_cselect_b32 s47, 8192, s46
    v_add_u32 v19, s46, v16
    v_add_u32 v20, s46, v17
    v_add_u32 v21, s47, v16
    v_add_u32 v22, s47, v17
    v_add_u32 v23, 147456, v18
    v_mfma_f32_16x16x32_bf16 v[112:115], v[48:51], v[76:79], v[112:115]
    ds_read_b64_tr_b16 v[36:37], v23 offset:4096
    v_mfma_f32_16x16x32_bf16 v[132:135], v[76:79], v[52:55], v[132:135]
    ds_read_b64_tr_b16 v[38:39], v23 offset:4352
    v_mfma_f32_16x16x32_bf16 v[116:119], v[48:51], v[80:83], v[116:119]
    ds_read_b64_tr_b16 v[40:41], v23 offset:8192
    v_mfma_f32_16x16x32_bf16 v[136:139], v[80:83], v[52:55], v[136:139]
    ds_read_b64_tr_b16 v[42:43], v23 offset:8448
    v_mfma_f32_16x16x32_bf16 v[96:99], v[44:47], v[80:83], v[96:99]
    v_mfma_f32_16x16x32_bf16 v[120:123], v[48:51], v[84:87], v[120:123]
    ds_read_b64_tr_b16 v[32:33], v23 offset:0
    v_mfma_f32_16x16x32_bf16 v[140:143], v[84:87], v[52:55], v[140:143]
    ds_read_b64_tr_b16 v[34:35], v23 offset:256
    v_mfma_f32_16x16x32_bf16 v[100:103], v[44:47], v[84:87], v[100:103]
    ds_read_b128 v[56:59], v21
    v_mfma_f32_16x16x32_bf16 v[124:127], v[48:51], v[88:91], v[124:127]
    ds_read_b128 v[60:63], v19 offset:2048
    v_mfma_f32_16x16x32_bf16 v[144:147], v[88:91], v[52:55], v[144:147]
    v_mfma_f32_16x16x32_bf16 v[104:107], v[44:47], v[88:91], v[104:107]
    ds_read_b128 v[64:67], v19 offset:4096
    v_mfma_f32_16x16x32_bf16 v[128:131], v[48:51], v[92:95], v[128:131]
    ds_read_b128 v[68:71], v19 offset:6144
    v_mfma_f32_16x16x32_bf16 v[148:151], v[92:95], v[52:55], v[148:151]
    ds_read_b128 v[72:75], v19 offset:8192
    v_mfma_f32_16x16x32_bf16 v[108:111], v[44:47], v[92:95], v[108:111]
    s_waitcnt lgkmcnt(0)
    v_mfma_f32_16x16x32_bf16 v[112:115], v[36:39], v[56:59], v[112:115]
    ds_read_b64_tr_b16 v[48:49], v23 offset:6144
    v_mfma_f32_16x16x32_bf16 v[132:135], v[56:59], v[40:43], v[132:135]
    ds_read_b64_tr_b16 v[50:51], v23 offset:6400
    v_mfma_f32_16x16x32_bf16 v[116:119], v[36:39], v[60:63], v[116:119]
    ds_read_b64_tr_b16 v[52:53], v23 offset:10240
    v_mfma_f32_16x16x32_bf16 v[136:139], v[60:63], v[40:43], v[136:139]
    ds_read_b64_tr_b16 v[54:55], v23 offset:10496
    v_mfma_f32_16x16x32_bf16 v[96:99], v[32:35], v[60:63], v[96:99]
    v_mfma_f32_16x16x32_bf16 v[120:123], v[36:39], v[64:67], v[120:123]
    ds_read_b64_tr_b16 v[44:45], v23 offset:2048
    v_mfma_f32_16x16x32_bf16 v[140:143], v[64:67], v[40:43], v[140:143]
    ds_read_b64_tr_b16 v[46:47], v23 offset:2304
    v_mfma_f32_16x16x32_bf16 v[100:103], v[32:35], v[64:67], v[100:103]
    ds_read_b128 v[76:79], v22
    v_mfma_f32_16x16x32_bf16 v[124:127], v[36:39], v[68:71], v[124:127]
    ds_read_b128 v[80:83], v20 offset:2048
    v_mfma_f32_16x16x32_bf16 v[144:147], v[68:71], v[40:43], v[144:147]
    v_mfma_f32_16x16x32_bf16 v[104:107], v[32:35], v[68:71], v[104:107]
    ds_read_b128 v[84:87], v20 offset:4096
    v_mfma_f32_16x16x32_bf16 v[128:131], v[36:39], v[72:75], v[128:131]
    ds_read_b128 v[88:91], v20 offset:6144
    v_mfma_f32_16x16x32_bf16 v[148:151], v[72:75], v[40:43], v[148:151]
    ds_read_b128 v[92:95], v20 offset:8192
    v_mfma_f32_16x16x32_bf16 v[108:111], v[32:35], v[72:75], v[108:111]
    s_waitcnt lgkmcnt(0)
    s_barrier
    v_and_b32 v4, 255, v0
    v_lshlrev_b32 v5, 6, v4
    s_lshl_b32 s46, s4, 14
    buffer_load_dword v31, v5, s[16:19], s46 offen
    v_and_b32 v4, 255, v0
    s_movk_i32 s46, 4682
    v_mul_lo_u32 v5, v4, s46
    v_lshrrev_b32 v5, 16, v5
    v_mul_u32_u24 v6, 14, v5
    v_sub_u32 v6, v4, v6
    s_movk_i32 s46, 3584
    v_mul_lo_u32 v5, v5, s46
    v_lshl_add_u32 v5, v6, 7, v5
    s_mul_i32 s46, s4, 57344
    buffer_load_dword v31, v5, s[20:23], s46 offen
    s_lshl_b32 s46, s61, 13
    s_add_u32 s46, s46, 14336
    s_cmp_eq_u32 s61, 0
    s_cselect_b32 s47, 10240, s46
    v_add_u32 v19, s46, v16
    v_add_u32 v20, s46, v17
    v_add_u32 v21, s47, v16
    v_add_u32 v22, s47, v17
    v_add_u32 v23, 32768, v18
    v_mfma_f32_16x16x32_bf16 v[112:115], v[48:51], v[76:79], v[112:115]
    ds_read_b64_tr_b16 v[36:37], v23 offset:4096
    v_mfma_f32_16x16x32_bf16 v[132:135], v[76:79], v[52:55], v[132:135]
    ds_read_b64_tr_b16 v[38:39], v23 offset:4352
    v_mfma_f32_16x16x32_bf16 v[116:119], v[48:51], v[80:83], v[116:119]
    ds_read_b64_tr_b16 v[40:41], v23 offset:8192
    v_mfma_f32_16x16x32_bf16 v[136:139], v[80:83], v[52:55], v[136:139]
    ds_read_b64_tr_b16 v[42:43], v23 offset:8448
    v_mfma_f32_16x16x32_bf16 v[96:99], v[44:47], v[80:83], v[96:99]
    v_mfma_f32_16x16x32_bf16 v[120:123], v[48:51], v[84:87], v[120:123]
    ds_read_b64_tr_b16 v[32:33], v23 offset:0
    v_mfma_f32_16x16x32_bf16 v[140:143], v[84:87], v[52:55], v[140:143]
    ds_read_b64_tr_b16 v[34:35], v23 offset:256
    v_mfma_f32_16x16x32_bf16 v[100:103], v[44:47], v[84:87], v[100:103]
    ds_read_b128 v[56:59], v21
    v_mfma_f32_16x16x32_bf16 v[124:127], v[48:51], v[88:91], v[124:127]
    ds_read_b128 v[60:63], v19 offset:2048
    v_mfma_f32_16x16x32_bf16 v[144:147], v[88:91], v[52:55], v[144:147]
    v_mfma_f32_16x16x32_bf16 v[104:107], v[44:47], v[88:91], v[104:107]
    ds_read_b128 v[64:67], v19 offset:4096
    v_mfma_f32_16x16x32_bf16 v[128:131], v[48:51], v[92:95], v[128:131]
    ds_read_b128 v[68:71], v19 offset:6144
    v_mfma_f32_16x16x32_bf16 v[148:151], v[92:95], v[52:55], v[148:151]
    ds_read_b128 v[72:75], v19 offset:8192
    v_mfma_f32_16x16x32_bf16 v[108:111], v[44:47], v[92:95], v[108:111]
    s_waitcnt lgkmcnt(0)
    v_mfma_f32_16x16x32_bf16 v[112:115], v[36:39], v[56:59], v[112:115]
    ds_read_b64_tr_b16 v[48:49], v23 offset:6144
    v_mfma_f32_16x16x32_bf16 v[132:135], v[56:59], v[40:43], v[132:135]
    ds_read_b64_tr_b16 v[50:51], v23 offset:6400
    v_mfma_f32_16x16x32_bf16 v[116:119], v[36:39], v[60:63], v[116:119]
    ds_read_b64_tr_b16 v[52:53], v23 offset:10240
    v_mfma_f32_16x16x32_bf16 v[136:139], v[60:63], v[40:43], v[136:139]
    ds_read_b64_tr_b16 v[54:55], v23 offset:10496
    v_mfma_f32_16x16x32_bf16 v[96:99], v[32:35], v[60:63], v[96:99]
    v_mfma_f32_16x16x32_bf16 v[120:123], v[36:39], v[64:67], v[120:123]
    ds_read_b64_tr_b16 v[44:45], v23 offset:2048
    v_mfma_f32_16x16x32_bf16 v[140:143], v[64:67], v[40:43], v[140:143]
    ds_read_b64_tr_b16 v[46:47], v23 offset:2304
    v_mfma_f32_16x16x32_bf16 v[100:103], v[32:35], v[64:67], v[100:103]
    ds_read_b128 v[76:79], v22
    v_mfma_f32_16x16x32_bf16 v[124:127], v[36:39], v[68:71], v[124:127]
    ds_read_b128 v[80:83], v20 offset:2048
    v_mfma_f32_16x16x32_bf16 v[144:147], v[68:71], v[40:43], v[144:147]
    v_mfma_f32_16x16x32_bf16 v[104:107], v[32:35], v[68:71], v[104:107]
    ds_read_b128 v[84:87], v20 offset:4096
    v_mfma_f32_16x16x32_bf16 v[128:131], v[36:39], v[72:75], v[128:131]
    ds_read_b128 v[88:91], v20 offset:6144
    v_mfma_f32_16x16x32_bf16 v[148:151], v[72:75], v[40:43], v[148:151]
    ds_read_b128 v[92:95], v20 offset:8192
    v_mfma_f32_16x16x32_bf16 v[108:111], v[32:35], v[72:75], v[108:111]
    s_waitcnt lgkmcnt(0)
    s_barrier
    v_and_b32 v4, 255, v0
    s_movk_i32 s46, 4682
    v_mul_lo_u32 v5, v4, s46
    v_lshrrev_b32 v5, 16, v5
    v_mul_u32_u24 v6, 14, v5
    v_sub_u32 v6, v4, v6
    s_movk_i32 s46, 3584
    v_mul_lo_u32 v5, v5, s46
    v_lshl_add_u32 v5, v6, 7, v5
    s_mul_i32 s46, s4, 57344
    s_add_u32 s46, s46, 1792
    buffer_load_dword v31, v5, s[20:23], s46 offen
    s_lshl_b32 s46, s61, 13
    s_add_u32 s46, s46, 43008
    s_cmp_eq_u32 s61, 0
    s_cselect_b32 s47, 12288, s46
    v_add_u32 v19, s46, v16
    v_add_u32 v20, s46, v17
    v_add_u32 v21, s47, v16
    v_add_u32 v22, s47, v17
    v_add_u32 v23, 61440, v18
    v_mfma_f32_16x16x32_bf16 v[112:115], v[48:51], v[76:79], v[112:115]
    ds_read_b64_tr_b16 v[36:37], v23 offset:4096
    v_mfma_f32_16x16x32_bf16 v[132:135], v[76:79], v[52:55], v[132:135]
    ds_read_b64_tr_b16 v[38:39], v23 offset:4352
    v_mfma_f32_16x16x32_bf16 v[116:119], v[48:51], v[80:83], v[116:119]
    ds_read_b64_tr_b16 v[40:41], v23 offset:8192
    v_mfma_f32_16x16x32_bf16 v[136:139], v[80:83], v[52:55], v[136:139]
    ds_read_b64_tr_b16 v[42:43], v23 offset:8448
    v_mfma_f32_16x16x32_bf16 v[96:99], v[44:47], v[80:83], v[96:99]
    v_mfma_f32_16x16x32_bf16 v[120:123], v[48:51], v[84:87], v[120:123]
    ds_read_b64_tr_b16 v[32:33], v23 offset:0
    v_mfma_f32_16x16x32_bf16 v[140:143], v[84:87], v[52:55], v[140:143]
    ds_read_b64_tr_b16 v[34:35], v23 offset:256
    v_mfma_f32_16x16x32_bf16 v[100:103], v[44:47], v[84:87], v[100:103]
    ds_read_b128 v[56:59], v21
    v_mfma_f32_16x16x32_bf16 v[124:127], v[48:51], v[88:91], v[124:127]
    ds_read_b128 v[60:63], v19 offset:2048
    v_mfma_f32_16x16x32_bf16 v[144:147], v[88:91], v[52:55], v[144:147]
    v_mfma_f32_16x16x32_bf16 v[104:107], v[44:47], v[88:91], v[104:107]
    ds_read_b128 v[64:67], v19 offset:4096
    v_mfma_f32_16x16x32_bf16 v[128:131], v[48:51], v[92:95], v[128:131]
    ds_read_b128 v[68:71], v19 offset:6144
    v_mfma_f32_16x16x32_bf16 v[148:151], v[92:95], v[52:55], v[148:151]
    ds_read_b128 v[72:75], v19 offset:8192
    v_mfma_f32_16x16x32_bf16 v[108:111], v[44:47], v[92:95], v[108:111]
    s_waitcnt lgkmcnt(0)
    v_mfma_f32_16x16x32_bf16 v[112:115], v[36:39], v[56:59], v[112:115]
    ds_read_b64_tr_b16 v[48:49], v23 offset:6144
    v_mfma_f32_16x16x32_bf16 v[132:135], v[56:59], v[40:43], v[132:135]
    ds_read_b64_tr_b16 v[50:51], v23 offset:6400
    v_mfma_f32_16x16x32_bf16 v[116:119], v[36:39], v[60:63], v[116:119]
    ds_read_b64_tr_b16 v[52:53], v23 offset:10240
    v_mfma_f32_16x16x32_bf16 v[136:139], v[60:63], v[40:43], v[136:139]
    ds_read_b64_tr_b16 v[54:55], v23 offset:10496
    v_mfma_f32_16x16x32_bf16 v[96:99], v[32:35], v[60:63], v[96:99]
    v_mfma_f32_16x16x32_bf16 v[120:123], v[36:39], v[64:67], v[120:123]
    ds_read_b64_tr_b16 v[44:45], v23 offset:2048
    v_mfma_f32_16x16x32_bf16 v[140:143], v[64:67], v[40:43], v[140:143]
    ds_read_b64_tr_b16 v[46:47], v23 offset:2304
    v_mfma_f32_16x16x32_bf16 v[100:103], v[32:35], v[64:67], v[100:103]
    ds_read_b128 v[76:79], v22
    v_mfma_f32_16x16x32_bf16 v[124:127], v[36:39], v[68:71], v[124:127]
    ds_read_b128 v[80:83], v20 offset:2048
    v_mfma_f32_16x16x32_bf16 v[144:147], v[68:71], v[40:43], v[144:147]
    v_mfma_f32_16x16x32_bf16 v[104:107], v[32:35], v[68:71], v[104:107]
    ds_read_b128 v[84:87], v20 offset:4096
    v_mfma_f32_16x16x32_bf16 v[128:131], v[36:39], v[72:75], v[128:131]
    ds_read_b128 v[88:91], v20 offset:6144
    v_mfma_f32_16x16x32_bf16 v[148:151], v[72:75], v[40:43], v[148:151]
    ds_read_b128 v[92:95], v20 offset:8192
    v_mfma_f32_16x16x32_bf16 v[108:111], v[32:35], v[72:75], v[108:111]
    s_waitcnt lgkmcnt(0)
    s_barrier
    s_lshl_b32 s46, s61, 13
    s_add_u32 s46, s46, 71680
    s_cmp_eq_u32 s61, 0
    s_cselect_b32 s47, 14336, s46
    v_add_u32 v19, s46, v16
    v_add_u32 v20, s46, v17
    v_add_u32 v21, s47, v16
    v_add_u32 v22, s47, v17
    v_add_u32 v23, 90112, v18
    v_mfma_f32_16x16x32_bf16 v[112:115], v[48:51], v[76:79], v[112:115]
    ds_read_b64_tr_b16 v[36:37], v23 offset:4096
    v_mfma_f32_16x16x32_bf16 v[132:135], v[76:79], v[52:55], v[132:135]
    ds_read_b64_tr_b16 v[38:39], v23 offset:4352
    v_mfma_f32_16x16x32_bf16 v[116:119], v[48:51], v[80:83], v[116:119]
    ds_read_b64_tr_b16 v[40:41], v23 offset:8192
    v_mfma_f32_16x16x32_bf16 v[136:139], v[80:83], v[52:55], v[136:139]
    ds_read_b64_tr_b16 v[42:43], v23 offset:8448
    v_mfma_f32_16x16x32_bf16 v[96:99], v[44:47], v[80:83], v[96:99]
    v_mfma_f32_16x16x32_bf16 v[120:123], v[48:51], v[84:87], v[120:123]
    ds_read_b64_tr_b16 v[32:33], v23 offset:0
    v_mfma_f32_16x16x32_bf16 v[140:143], v[84:87], v[52:55], v[140:143]
    ds_read_b64_tr_b16 v[34:35], v23 offset:256
    v_mfma_f32_16x16x32_bf16 v[100:103], v[44:47], v[84:87], v[100:103]
    ds_read_b128 v[56:59], v21
    v_mfma_f32_16x16x32_bf16 v[124:127], v[48:51], v[88:91], v[124:127]
    ds_read_b128 v[60:63], v19 offset:2048
    v_mfma_f32_16x16x32_bf16 v[144:147], v[88:91], v[52:55], v[144:147]
    v_mfma_f32_16x16x32_bf16 v[104:107], v[44:47], v[88:91], v[104:107]
    ds_read_b128 v[64:67], v19 offset:4096
    v_mfma_f32_16x16x32_bf16 v[128:131], v[48:51], v[92:95], v[128:131]
    ds_read_b128 v[68:71], v19 offset:6144
    v_mfma_f32_16x16x32_bf16 v[148:151], v[92:95], v[52:55], v[148:151]
    ds_read_b128 v[72:75], v19 offset:8192
    v_mfma_f32_16x16x32_bf16 v[108:111], v[44:47], v[92:95], v[108:111]
    s_waitcnt lgkmcnt(0)
    v_mfma_f32_16x16x32_bf16 v[112:115], v[36:39], v[56:59], v[112:115]
    ds_read_b64_tr_b16 v[48:49], v23 offset:6144
    v_mfma_f32_16x16x32_bf16 v[132:135], v[56:59], v[40:43], v[132:135]
    ds_read_b64_tr_b16 v[50:51], v23 offset:6400
    v_mfma_f32_16x16x32_bf16 v[116:119], v[36:39], v[60:63], v[116:119]
    ds_read_b64_tr_b16 v[52:53], v23 offset:10240
    v_mfma_f32_16x16x32_bf16 v[136:139], v[60:63], v[40:43], v[136:139]
    ds_read_b64_tr_b16 v[54:55], v23 offset:10496
    v_mfma_f32_16x16x32_bf16 v[96:99], v[32:35], v[60:63], v[96:99]
    v_mfma_f32_16x16x32_bf16 v[120:123], v[36:39], v[64:67], v[120:123]
    ds_read_b64_tr_b16 v[44:45], v23 offset:2048
    v_mfma_f32_16x16x32_bf16 v[140:143], v[64:67], v[40:43], v[140:143]
    ds_read_b64_tr_b16 v[46:47], v23 offset:2304
    v_mfma_f32_16x16x32_bf16 v[100:103], v[32:35], v[64:67], v[100:103]
    ds_read_b128 v[76:79], v22
    v_mfma_f32_16x16x32_bf16 v[124:127], v[36:39], v[68:71], v[124:127]
    ds_read_b128 v[80:83], v20 offset:2048
    v_mfma_f32_16x16x32_bf16 v[144:147], v[68:71], v[40:43], v[144:147]
    v_mfma_f32_16x16x32_bf16 v[104:107], v[32:35], v[68:71], v[104:107]
    ds_read_b128 v[84:87], v20 offset:4096
    v_mfma_f32_16x16x32_bf16 v[128:131], v[36:39], v[72:75], v[128:131]
    ds_read_b128 v[88:91], v20 offset:6144
    v_mfma_f32_16x16x32_bf16 v[148:151], v[72:75], v[40:43], v[148:151]
    ds_read_b128 v[92:95], v20 offset:8192
    v_mfma_f32_16x16x32_bf16 v[108:111], v[32:35], v[72:75], v[108:111]
    s_waitcnt lgkmcnt(0)
    v_mfma_f32_16x16x32_bf16 v[112:115], v[48:51], v[76:79], v[112:115]
    v_mfma_f32_16x16x32_bf16 v[132:135], v[76:79], v[52:55], v[132:135]
    v_mfma_f32_16x16x32_bf16 v[116:119], v[48:51], v[80:83], v[116:119]
    v_mfma_f32_16x16x32_bf16 v[136:139], v[80:83], v[52:55], v[136:139]
    v_mfma_f32_16x16x32_bf16 v[96:99], v[44:47], v[80:83], v[96:99]
    v_mfma_f32_16x16x32_bf16 v[120:123], v[48:51], v[84:87], v[120:123]
    v_mfma_f32_16x16x32_bf16 v[140:143], v[84:87], v[52:55], v[140:143]
    v_mfma_f32_16x16x32_bf16 v[100:103], v[44:47], v[84:87], v[100:103]
    v_mfma_f32_16x16x32_bf16 v[124:127], v[48:51], v[88:91], v[124:127]
    v_mfma_f32_16x16x32_bf16 v[144:147], v[88:91], v[52:55], v[144:147]
    v_mfma_f32_16x16x32_bf16 v[104:107], v[44:47], v[88:91], v[104:107]
    v_mfma_f32_16x16x32_bf16 v[128:131], v[48:51], v[92:95], v[128:131]
    v_mfma_f32_16x16x32_bf16 v[148:151], v[92:95], v[52:55], v[148:151]
    v_mfma_f32_16x16x32_bf16 v[108:111], v[44:47], v[92:95], v[108:111]
    s_barrier
    v_mov_b32 v6, 163816
    ds_read_b64 v[4:5], v6
    s_waitcnt lgkmcnt(0)
    v_readfirstlane_b32 s101, v4
    v_readfirstlane_b32 s99, v5
    s_mul_i32 s46, s61, 512
    s_add_u32 s46, s46, 159744
    v_lshlrev_b32 v4, 3, v2
    v_add_u32 v6, s46, v4
    ds_read_b64 v[164:165], v6 offset:0
    ds_read_b64 v[166:167], v6 offset:128
    ds_read_b64 v[168:169], v6 offset:256
    ds_read_b64 v[170:171], v6 offset:384
    ds_read_b64 v[172:173], v6 offset:512
    s_lshl_b32 s46, s60, 6
    s_add_u32 s46, s46, 160896
    v_lshlrev_b32 v5, 4, v3
    v_add_u32 v5, s46, v5
    v_lshlrev_b32 v6, 2, v2
    v_add_u32 v6, s46, v6
    ds_read_b128 v[176:179], v5 offset:0
    ds_read_b128 v[180:183], v5 offset:128
    ds_read_b32 v184, v6 offset:256
    ds_read_b128 v[188:191], v5 offset:384
    ds_read_b128 v[192:195], v5 offset:512
    ds_read_b32 v196, v6 offset:640
    s_waitcnt lgkmcnt(0)
    s_mov_b32 s50, 0x3b000000
    s_mov_b32 s51, 0x3727c5ac
    v_mul_f32 v164, s50, v164
    v_mul_f32 v166, s50, v166
    v_mul_f32 v168, s50, v168
    v_mul_f32 v170, s50, v170
    v_mul_f32 v172, s50, v172
    v_mul_f32 v165, s50, v165
    v_mul_f32 v167, s50, v167
    v_mul_f32 v169, s50, v169
    v_mul_f32 v171, s50, v171
    v_mul_f32 v173, s50, v173
    v_fma_f32 v165, -v164, v164, v165
    v_fma_f32 v167, -v166, v166, v167
    v_fma_f32 v169, -v168, v168, v169
    v_fma_f32 v171, -v170, v170, v171
    v_fma_f32 v173, -v172, v172, v173
    v_max_f32 v165, 0, v165
    v_max_f32 v167, 0, v167
    v_max_f32 v169, 0, v169
    v_max_f32 v171, 0, v171
    v_max_f32 v173, 0, v173
    v_add_f32 v165, s51, v165
    v_add_f32 v167, s51, v167
    v_add_f32 v169, s51, v169
    v_add_f32 v171, s51, v171
    v_add_f32 v173, s51, v173
    v_rsq_f32 v200, v165
    v_rsq_f32 v202, v167
    v_rsq_f32 v204, v169
    v_rsq_f32 v206, v171
    v_rsq_f32 v208, v173
    v_mul_f32 v201, -v164, v200
    v_mul_f32 v203, -v166, v202
    v_mul_f32 v205, -v168, v204
    v_mul_f32 v207, -v170, v206
    v_mul_f32 v209, -v172, v208
    s_mul_i32 s46, s44, 640
    s_add_u32 s46, s46, 0
    v_add_u32 v5, s46, v4
    ds_write_b64 v5, v[200:201] offset:0
    ds_write_b64 v5, v[202:203] offset:128
    ds_write_b64 v5, v[204:205] offset:256
    ds_write_b64 v5, v[206:207] offset:384
    ds_write_b64 v5, v[208:209] offset:512
    v_lshlrev_b32 v6, 5, v3
    v_add_u32 v6, s46, v6
    v_add_f32 v176, v176, v188
    v_add_f32 v177, v177, v189
    v_add_f32 v178, v178, v190
    v_add_f32 v179, v179, v191
    v_add_f32 v180, v180, v192
    v_add_f32 v181, v181, v193
    v_add_f32 v182, v182, v194
    v_add_f32 v183, v183, v195
    v_add_f32 v184, v184, v196
    s_waitcnt lgkmcnt(0)
    ds_read_b128 v[212:215], v6 offset:0
    ds_read_b128 v[216:219], v6 offset:16
    ds_read_b128 v[220:223], v6 offset:128
    ds_read_b128 v[224:227], v6 offset:144
    ds_read_b128 v[228:231], v6 offset:256
    ds_read_b128 v[232:235], v6 offset:272
    ds_read_b128 v[236:239], v6 offset:384
    ds_read_b128 v[240:243], v6 offset:400
    ds_read_b128 v[244:247], v6 offset:512
    ds_read_b128 v[248:251], v6 offset:528
    v_mul_f32 v164, 0.25, v202
    v_mul_f32 v165, 0.25, v203
    v_mul_f32 v166, 0.25, v204
    v_mul_f32 v167, 0.25, v205
    v_mul_f32 v168, 0.25, v206
    v_mul_f32 v169, 0.25, v207
    v_mul_f32 v170, 0.25, v208
    v_mul_f32 v171, 0.25, v209
    v_pk_mul_f32 v[188:189], v[200:201], v[180:181] op_sel:[1,0] op_sel_hi:[1,1]
    v_pk_mul_f32 v[190:191], v[200:201], v[182:183] op_sel:[1,0] op_sel_hi:[1,1]
    v_pk_fma_f32 v[112:113], v[200:201], v[112:113], v[188:189] op_sel_hi:[0,1,1]
    v_pk_fma_f32 v[114:115], v[200:201], v[114:115], v[190:191] op_sel_hi:[0,1,1]
    v_pk_mul_f32 v[192:193], v[202:203], v[180:181] op_sel:[1,0] op_sel_hi:[1,1]
    v_pk_mul_f32 v[194:195], v[202:203], v[182:183] op_sel:[1,0] op_sel_hi:[1,1]
    v_pk_fma_f32 v[116:117], v[202:203], v[116:117], v[192:193] op_sel_hi:[0,1,1]
    v_pk_fma_f32 v[118:119], v[202:203], v[118:119], v[194:195] op_sel_hi:[0,1,1]
    v_pk_mul_f32 v[188:189], v[204:205], v[180:181] op_sel:[1,0] op_sel_hi:[1,1]
    v_pk_mul_f32 v[190:191], v[204:205], v[182:183] op_sel:[1,0] op_sel_hi:[1,1]
    v_pk_fma_f32 v[120:121], v[204:205], v[120:121], v[188:189] op_sel_hi:[0,1,1]
    v_pk_fma_f32 v[122:123], v[204:205], v[122:123], v[190:191] op_sel_hi:[0,1,1]
    v_pk_mul_f32 v[192:193], v[206:207], v[180:181] op_sel:[1,0] op_sel_hi:[1,1]
    v_pk_mul_f32 v[194:195], v[206:207], v[182:183] op_sel:[1,0] op_sel_hi:[1,1]
    v_pk_fma_f32 v[124:125], v[206:207], v[124:125], v[192:193] op_sel_hi:[0,1,1]
    v_pk_fma_f32 v[126:127], v[206:207], v[126:127], v[194:195] op_sel_hi:[0,1,1]
    v_pk_mul_f32 v[188:189], v[208:209], v[180:181] op_sel:[1,0] op_sel_hi:[1,1]
    v_pk_mul_f32 v[190:191], v[208:209], v[182:183] op_sel:[1,0] op_sel_hi:[1,1]
    v_pk_fma_f32 v[128:129], v[208:209], v[128:129], v[188:189] op_sel_hi:[0,1,1]
    v_pk_fma_f32 v[130:131], v[208:209], v[130:131], v[190:191] op_sel_hi:[0,1,1]
    v_pk_mul_f32 v[192:193], v[164:165], v[176:177] op_sel:[1,0] op_sel_hi:[1,1]
    v_pk_mul_f32 v[194:195], v[164:165], v[178:179] op_sel:[1,0] op_sel_hi:[1,1]
    v_pk_fma_f32 v[96:97], v[164:165], v[96:97], v[192:193] op_sel_hi:[0,1,1]
    v_pk_fma_f32 v[98:99], v[164:165], v[98:99], v[194:195] op_sel_hi:[0,1,1]
    v_pk_mul_f32 v[188:189], v[166:167], v[176:177] op_sel:[1,0] op_sel_hi:[1,1]
    v_pk_mul_f32 v[190:191], v[166:167], v[178:179] op_sel:[1,0] op_sel_hi:[1,1]
    v_pk_fma_f32 v[100:101], v[166:167], v[100:101], v[188:189] op_sel_hi:[0,1,1]
    v_pk_fma_f32 v[102:103], v[166:167], v[102:103], v[190:191] op_sel_hi:[0,1,1]
    v_pk_mul_f32 v[192:193], v[168:169], v[176:177] op_sel:[1,0] op_sel_hi:[1,1]
    v_pk_mul_f32 v[194:195], v[168:169], v[178:179] op_sel:[1,0] op_sel_hi:[1,1]
    v_pk_fma_f32 v[104:105], v[168:169], v[104:105], v[192:193] op_sel_hi:[0,1,1]
    v_pk_fma_f32 v[106:107], v[168:169], v[106:107], v[194:195] op_sel_hi:[0,1,1]
    v_pk_mul_f32 v[188:189], v[170:171], v[176:177] op_sel:[1,0] op_sel_hi:[1,1]
    v_pk_mul_f32 v[190:191], v[170:171], v[178:179] op_sel:[1,0] op_sel_hi:[1,1]
    v_pk_fma_f32 v[108:109], v[170:171], v[108:109], v[188:189] op_sel_hi:[0,1,1]
    v_pk_fma_f32 v[110:111], v[170:171], v[110:111], v[190:191] op_sel_hi:[0,1,1]
    v_cvt_pk_bf16_f32 v32, v112, v113
    v_cvt_pk_bf16_f32 v33, v114, v115
    v_cvt_pk_bf16_f32 v34, v116, v117
    v_cvt_pk_bf16_f32 v35, v118, v119
    v_cvt_pk_bf16_f32 v36, v120, v121
    v_cvt_pk_bf16_f32 v37, v122, v123
    v_cvt_pk_bf16_f32 v38, v124, v125
    v_cvt_pk_bf16_f32 v39, v126, v127
    v_cvt_pk_bf16_f32 v40, v128, v129
    v_cvt_pk_bf16_f32 v41, v130, v131
    v_cvt_pk_bf16_f32 v42, v96, v97
    v_cvt_pk_bf16_f32 v43, v98, v99
    v_cvt_pk_bf16_f32 v44, v100, v101
    v_cvt_pk_bf16_f32 v45, v102, v103
    v_cvt_pk_bf16_f32 v46, v104, v105
    v_cvt_pk_bf16_f32 v47, v106, v107
    v_cvt_pk_bf16_f32 v48, v108, v109
    v_cvt_pk_bf16_f32 v49, v110, v111
    v_mfma_f32_16x16x16_bf16 v[96:99], v[34:35], v[42:43], v[152:155]
    v_mfma_f32_16x16x16_bf16 v[100:103], v[32:33], v[42:43], v[160:163]
    v_mfma_f32_16x16x16_bf16 v[104:107], v[36:37], v[44:45], v[152:155]
    v_mfma_f32_16x16x16_bf16 v[108:111], v[34:35], v[44:45], v[156:159]
    v_mfma_f32_16x16x16_bf16 v[112:115], v[38:39], v[46:47], v[152:155]
    v_mfma_f32_16x16x16_bf16 v[116:119], v[36:37], v[46:47], v[156:159]
    v_mfma_f32_16x16x16_bf16 v[120:123], v[40:41], v[48:49], v[152:155]
    v_mfma_f32_16x16x16_bf16 v[124:127], v[38:39], v[48:49], v[156:159]
    s_waitcnt lgkmcnt(0)
    v_mul_f32 v188, v213, v184
    v_mul_f32 v189, v215, v184
    v_mul_f32 v190, v217, v184
    v_mul_f32 v191, v219, v184
    v_fma_f32 v132, v212, v132, v188
    v_fma_f32 v133, v214, v133, v189
    v_fma_f32 v134, v216, v134, v190
    v_fma_f32 v135, v218, v135, v191
    v_mul_f32 v192, v221, v184
    v_mul_f32 v193, v223, v184
    v_mul_f32 v194, v225, v184
    v_mul_f32 v195, v227, v184
    v_fma_f32 v136, v220, v136, v192
    v_fma_f32 v137, v222, v137, v193
    v_fma_f32 v138, v224, v138, v194
    v_fma_f32 v139, v226, v139, v195
    v_mul_f32 v188, v229, v184
    v_mul_f32 v189, v231, v184
    v_mul_f32 v190, v233, v184
    v_mul_f32 v191, v235, v184
    v_fma_f32 v140, v228, v140, v188
    v_fma_f32 v141, v230, v141, v189
    v_fma_f32 v142, v232, v142, v190
    v_fma_f32 v143, v234, v143, v191
    v_mul_f32 v192, v237, v184
    v_mul_f32 v193, v239, v184
    v_mul_f32 v194, v241, v184
    v_mul_f32 v195, v243, v184
    v_fma_f32 v144, v236, v144, v192
    v_fma_f32 v145, v238, v145, v193
    v_fma_f32 v146, v240, v146, v194
    v_fma_f32 v147, v242, v147, v195
    v_mul_f32 v188, v245, v184
    v_mul_f32 v189, v247, v184
    v_mul_f32 v190, v249, v184
    v_mul_f32 v191, v251, v184
    v_fma_f32 v148, v244, v148, v188
    v_fma_f32 v149, v246, v149, v189
    v_fma_f32 v150, v248, v150, v190
    v_fma_f32 v151, v250, v151, v191
    v_cvt_pk_bf16_f32 v50, v132, v133
    v_cvt_pk_bf16_f32 v51, v134, v135
    v_cvt_pk_bf16_f32 v52, v136, v137
    v_cvt_pk_bf16_f32 v53, v138, v139
    v_cvt_pk_bf16_f32 v54, v140, v141
    v_cvt_pk_bf16_f32 v55, v142, v143
    v_cvt_pk_bf16_f32 v56, v144, v145
    v_cvt_pk_bf16_f32 v57, v146, v147
    v_cvt_pk_bf16_f32 v58, v148, v149
    v_cvt_pk_bf16_f32 v59, v150, v151
    v_max3_f32 v128, v96, v97, v98
    v_max3_f32 v129, v104, v105, v106
    v_max3_f32 v130, v112, v113, v114
    v_max3_f32 v131, v120, v121, v122
    v_max3_f32 v60, v99, v100, v101
    v_max3_f32 v61, v107, v108, v109
    v_max3_f32 v62, v115, v116, v117
    v_max3_f32 v63, v123, v124, v125
    v_max3_f32 v128, v128, v102, v103
    v_max3_f32 v129, v129, v110, v111
    v_max3_f32 v130, v130, v118, v119
    v_max3_f32 v131, v131, v126, v127
    v_max_f32 v128, v128, v60
    v_max_f32 v129, v129, v61
    v_max_f32 v130, v130, v62
    v_max_f32 v131, v131, v63
    v_mov_b32 v136, v128
    v_mov_b32 v137, v129
    v_mov_b32 v138, v130
    v_mov_b32 v139, v131
    v_permlane32_swap_b32 v128, v136
    v_permlane32_swap_b32 v129, v137
    v_permlane32_swap_b32 v130, v138
    v_permlane32_swap_b32 v131, v139
    v_max_f32 v128, v128, v136
    v_max_f32 v129, v129, v137
    v_max_f32 v130, v130, v138
    v_max_f32 v131, v131, v139
    v_mov_b32 v136, v128
    v_mov_b32 v137, v129
    v_mov_b32 v138, v130
    v_mov_b32 v139, v131
    v_permlane16_swap_b32 v128, v136
    v_permlane16_swap_b32 v129, v137
    v_permlane16_swap_b32 v130, v138
    v_permlane16_swap_b32 v131, v139
    v_max_f32 v128, v128, v136
    v_max_f32 v129, v129, v137
    v_max_f32 v130, v130, v138
    v_max_f32 v131, v131, v139
    s_mov_b32 s50, 0x3fb8aa3b
    v_mul_f32 v128, s50, v128
    v_mul_f32 v129, s50, v129
    v_mul_f32 v130, s50, v130
    v_mul_f32 v131, s50, v131
    v_fma_f32 v96, v96, s50, -v128
    v_fma_f32 v97, v97, s50, -v128
    v_fma_f32 v98, v98, s50, -v128
    v_fma_f32 v99, v99, s50, -v128
    v_fma_f32 v100, v100, s50, -v128
    v_fma_f32 v101, v101, s50, -v128
    v_fma_f32 v102, v102, s50, -v128
    v_fma_f32 v103, v103, s50, -v128
    v_fma_f32 v104, v104, s50, -v129
    v_fma_f32 v105, v105, s50, -v129
    v_fma_f32 v106, v106, s50, -v129
    v_fma_f32 v107, v107, s50, -v129
    v_fma_f32 v108, v108, s50, -v129
    v_fma_f32 v109, v109, s50, -v129
    v_fma_f32 v110, v110, s50, -v129
    v_fma_f32 v111, v111, s50, -v129
    v_fma_f32 v112, v112, s50, -v130
    v_fma_f32 v113, v113, s50, -v130
    v_fma_f32 v114, v114, s50, -v130
    v_fma_f32 v115, v115, s50, -v130
    v_fma_f32 v116, v116, s50, -v130
    v_fma_f32 v117, v117, s50, -v130
    v_fma_f32 v118, v118, s50, -v130
    v_fma_f32 v119, v119, s50, -v130
    v_fma_f32 v120, v120, s50, -v131
    v_fma_f32 v121, v121, s50, -v131
    v_fma_f32 v122, v122, s50, -v131
    v_fma_f32 v123, v123, s50, -v131
    v_fma_f32 v124, v124, s50, -v131
    v_fma_f32 v125, v125, s50, -v131
    v_fma_f32 v126, v126, s50, -v131
    v_fma_f32 v127, v127, s50, -v131
    v_exp_f32 v96, v96
    v_exp_f32 v97, v97
    v_exp_f32 v98, v98
    v_exp_f32 v99, v99
    v_exp_f32 v100, v100
    v_exp_f32 v101, v101
    v_exp_f32 v102, v102
    v_exp_f32 v103, v103
    v_exp_f32 v104, v104
    v_exp_f32 v105, v105
    v_exp_f32 v106, v106
    v_exp_f32 v107, v107
    v_exp_f32 v108, v108
    v_exp_f32 v109, v109
    v_exp_f32 v110, v110
    v_exp_f32 v111, v111
    v_exp_f32 v112, v112
    v_exp_f32 v113, v113
    v_exp_f32 v114, v114
    v_exp_f32 v115, v115
    v_exp_f32 v116, v116
    v_exp_f32 v117, v117
    v_exp_f32 v118, v118
    v_exp_f32 v119, v119
    v_exp_f32 v120, v120
    v_exp_f32 v121, v121
    v_exp_f32 v122, v122
    v_exp_f32 v123, v123
    v_exp_f32 v124, v124
    v_exp_f32 v125, v125
    v_exp_f32 v126, v126
    v_exp_f32 v127, v127
    v_cvt_pk_bf16_f32 v140, v96, v97
    v_cvt_pk_bf16_f32 v141, v98, v99
    v_cvt_pk_bf16_f32 v142, v100, v101
    v_cvt_pk_bf16_f32 v143, v102, v103
    v_cvt_pk_bf16_f32 v144, v104, v105
    v_cvt_pk_bf16_f32 v145, v106, v107
    v_cvt_pk_bf16_f32 v146, v108, v109
    v_cvt_pk_bf16_f32 v147, v110, v111
    v_cvt_pk_bf16_f32 v148, v112, v113
    v_cvt_pk_bf16_f32 v149, v114, v115
    v_cvt_pk_bf16_f32 v150, v116, v117
    v_cvt_pk_bf16_f32 v151, v118, v119
    v_cvt_pk_bf16_f32 v152, v120, v121
    v_cvt_pk_bf16_f32 v153, v122, v123
    v_cvt_pk_bf16_f32 v154, v124, v125
    v_cvt_pk_bf16_f32 v155, v126, v127
    v_mfma_f32_16x16x16_bf16 v[196:199], v[52:53], v[140:141], 0
    v_mfma_f32_16x16x16_bf16 v[200:203], v[54:55], v[144:145], 0
    v_mfma_f32_16x16x16_bf16 v[204:207], v[56:57], v[148:149], 0
    v_mfma_f32_16x16x16_bf16 v[208:211], v[58:59], v[152:153], 0
    v_mfma_f32_16x16x16_bf16 v[196:199], v[50:51], v[142:143], v[196:199]
    v_mfma_f32_16x16x16_bf16 v[200:203], v[52:53], v[146:147], v[200:203]
    v_mfma_f32_16x16x16_bf16 v[204:207], v[54:55], v[150:151], v[204:207]
    v_mfma_f32_16x16x16_bf16 v[208:211], v[56:57], v[154:155], v[208:211]
    v_add_f32 v132, v96, v97
    v_add_f32 v60, v98, v99
    v_add_f32 v133, v104, v105
    v_add_f32 v61, v106, v107
    v_add_f32 v134, v112, v113
    v_add_f32 v62, v114, v115
    v_add_f32 v135, v120, v121
    v_add_f32 v63, v122, v123
    v_add_f32 v132, v132, v100
    v_add_f32 v60, v60, v101
    v_add_f32 v133, v133, v108
    v_add_f32 v61, v61, v109
    v_add_f32 v134, v134, v116
    v_add_f32 v62, v62, v117
    v_add_f32 v135, v135, v124
    v_add_f32 v63, v63, v125
    v_add_f32 v132, v132, v102
    v_add_f32 v60, v60, v103
    v_add_f32 v133, v133, v110
    v_add_f32 v61, v61, v111
    v_add_f32 v134, v134, v118
    v_add_f32 v62, v62, v119
    v_add_f32 v135, v135, v126
    v_add_f32 v63, v63, v127
    v_add_f32 v132, v132, v60
    v_add_f32 v133, v133, v61
    v_add_f32 v134, v134, v62
    v_add_f32 v135, v135, v63
    v_mov_b32 v136, v132
    v_mov_b32 v137, v133
    v_mov_b32 v138, v134
    v_mov_b32 v139, v135
    v_permlane32_swap_b32 v132, v136
    v_permlane32_swap_b32 v133, v137
    v_permlane32_swap_b32 v134, v138
    v_permlane32_swap_b32 v135, v139
    v_add_f32 v132, v132, v136
    v_add_f32 v133, v133, v137
    v_add_f32 v134, v134, v138
    v_add_f32 v135, v135, v139
    v_mov_b32 v136, v132
    v_mov_b32 v137, v133
    v_mov_b32 v138, v134
    v_mov_b32 v139, v135
    v_permlane16_swap_b32 v132, v136
    v_permlane16_swap_b32 v133, v137
    v_permlane16_swap_b32 v134, v138
    v_permlane16_swap_b32 v135, v139
    v_add_f32 v132, v132, v136
    v_add_f32 v133, v133, v137
    v_add_f32 v134, v134, v138
    v_add_f32 v135, v135, v139
    v_rcp_f32 v132, v132
    v_rcp_f32 v133, v133
    v_rcp_f32 v134, v134
    v_rcp_f32 v135, v135
    s_lshl_b32 s46, s40, 3
    s_lshl_b32 s47, s61, 2
    s_add_u32 s46, s46, s47
    s_lshl_b32 s46, s46, 14
    s_lshl_b32 s47, s41, 10
    s_add_u32 s46, s46, s47
    s_lshl_b32 s47, s60, 3
    s_add_u32 s46, s46, s47
    v_mul_f32 v196, v132, v196
    v_mul_f32 v197, v132, v197
    v_mul_f32 v198, v132, v198
    v_mul_f32 v199, v132, v199
    v_cvt_pk_bf16_f32 v180, v196, v197
    v_cvt_pk_bf16_f32 v181, v198, v199
    v_mul_f32 v200, v133, v200
    v_mul_f32 v201, v133, v201
    v_mul_f32 v202, v133, v202
    v_mul_f32 v203, v133, v203
    v_cvt_pk_bf16_f32 v182, v200, v201
    v_cvt_pk_bf16_f32 v183, v202, v203
    v_mul_f32 v204, v134, v204
    v_mul_f32 v205, v134, v205
    v_mul_f32 v206, v134, v206
    v_mul_f32 v207, v134, v207
    v_cvt_pk_bf16_f32 v184, v204, v205
    v_cvt_pk_bf16_f32 v185, v206, v207
    v_mul_f32 v208, v135, v208
    v_mul_f32 v209, v135, v209
    v_mul_f32 v210, v135, v210
    v_mul_f32 v211, v135, v211
    v_cvt_pk_bf16_f32 v186, v208, v209
    v_cvt_pk_bf16_f32 v187, v210, v211
    s_add_u32 s47, s46, 16384
    s_add_u32 s48, s46, 32768
    s_add_u32 s49, s46, 49152
    s_cmp_eq_u32 s101, 0
    s_cbranch_scc1 L_dsl0
    buffer_store_dwordx2 v[180:181], v7, s[32:35], s46 offen
    buffer_store_dwordx2 v[182:183], v7, s[32:35], s47 offen
    buffer_store_dwordx2 v[184:185], v7, s[32:35], s48 offen
    buffer_store_dwordx2 v[186:187], v7, s[32:35], s49 offen
    s_branch L_djn0
L_dsl0:
    buffer_store_dwordx2 v[180:181], v7, s[32:35], s46 offen sc1
    buffer_store_dwordx2 v[182:183], v7, s[32:35], s47 offen sc1
    buffer_store_dwordx2 v[184:185], v7, s[32:35], s48 offen sc1
    buffer_store_dwordx2 v[186:187], v7, s[32:35], s49 offen sc1
L_djn0:
    s_waitcnt vmcnt(0)
    s_mov_b64 exec, 1
    v_mov_b32 v5, 162304
    v_mov_b32 v4, 1
    ds_add_rtn_u32 v6, v5, v4
    s_waitcnt lgkmcnt(0)
    v_readfirstlane_b32 s64, v6
    s_nop 1
    s_cmp_lg_u32 s64, 3
    s_cbranch_scc1 L_sg0
    v_mov_b32 v4, s99
    s_mov_b32 s64, 0
    s_cmp_eq_u32 s101, 0
    s_cbranch_scc1 L_dsl1
    buffer_store_dword v4, v8, s[32:35], s64 offen
    s_branch L_djn1
L_dsl1:
    buffer_store_dword v4, v8, s[32:35], s64 offen sc1
L_djn1:
L_sg0:
    s_mov_b64 exec, -1
    s_barrier
    s_cmp_eq_u32 s42, 0
    s_cbranch_scc1 L_w1skip
    s_add_u32 s7, s44, s5
    s_add_u32 s7, s7, 0
    s_and_b32 s7, s7, 15
    s_mul_i32 s7, s7, 114688
    s_add_u32 s7, s7, s67
    s_add_u32 m0, s68, 49152
    s_add_u32 s64, s7, 0
    buffer_load_dwordx4 v24, s[20:23], s64 offen lds
    s_add_u32 m0, s68, 50176
    s_add_u32 s64, s7, 0
    buffer_load_dwordx4 v25, s[20:23], s64 offen lds
    s_add_u32 m0, s68, 51200
    s_add_u32 s64, s7, 0
    buffer_load_dwordx4 v26, s[20:23], s64 offen lds
    s_add_u32 m0, s68, 52224
    s_add_u32 s64, s7, 0
    buffer_load_dwordx4 v27, s[20:23], s64 offen lds
    s_add_u32 m0, s68, 53248
    s_add_u32 s64, s7, 0
    buffer_load_dwordx4 v28, s[20:23], s64 offen lds
    s_add_u32 m0, s68, 54272
    s_add_u32 s64, s7, 0
    buffer_load_dwordx4 v29, s[20:23], s64 offen lds
    s_add_u32 m0, s68, 55296
    s_add_u32 s64, s7, 0
    buffer_load_dwordx4 v30, s[20:23], s64 offen lds
    s_add_u32 s7, s44, s5
    s_add_u32 s7, s7, 12
    s_and_b32 s7, s7, 15
    s_mul_i32 s7, s7, 114688
    s_add_u32 s7, s7, s67
    s_add_u32 m0, s68, 135168
    s_add_u32 s64, s7, 0
    buffer_load_dwordx4 v24, s[20:23], s64 offen lds
    s_add_u32 m0, s68, 136192
    s_add_u32 s64, s7, 0
    buffer_load_dwordx4 v25, s[20:23], s64 offen lds
    s_add_u32 m0, s68, 137216
    s_add_u32 s64, s7, 0
    buffer_load_dwordx4 v26, s[20:23], s64 offen lds
    s_add_u32 m0, s68, 138240
    s_add_u32 s64, s7, 0
    buffer_load_dwordx4 v27, s[20:23], s64 offen lds
    s_add_u32 m0, s68, 139264
    s_add_u32 s64, s7, 0
    buffer_load_dwordx4 v28, s[20:23], s64 offen lds
    s_add_u32 m0, s68, 140288
    s_add_u32 s64, s7, 0
    buffer_load_dwordx4 v29, s[20:23], s64 offen lds
    s_add_u32 m0, s68, 141312
    s_add_u32 s64, s7, 0
    buffer_load_dwordx4 v30, s[20:23], s64 offen lds
    v_and_b32 v4, 255, v0
    v_lshlrev_b32 v5, 7, v4
    s_mul_i32 s46, s4, 57344
    buffer_load_dword v31, v5, s[24:27], s46 offen
L_w1skip:
    s_cmp_lg_u32 s42, 0
    s_cbranch_scc1 L_pollA1_ok
    s_mov_b32 s58, 0
    s_lshl_b32 s64, s3, 8
    s_add_u32 s64, s64, 13631488
    v_and_b32 v5, 15, v1
    v_lshlrev_b32 v5, 2, v5
L_pollA1:
    buffer_load_dword v4, v5, s[32:35], s64 offen sc1
    s_waitcnt vmcnt(0)
    v_cmp_ne_u32 vcc, s99, v4
    s_add_u32 s58, s58, 1
    s_cbranch_vccz L_pollA1_ok
    s_sleep 1
    s_cmp_lt_u32 s58, 0x8000
    s_cbranch_scc1 L_pollA1
L_pollA1_ok:
    s_barrier
    s_cmp_lg_u32 s42, 0
    s_cbranch_scc1 L_w1skip2
    s_add_u32 s7, s44, s5
    s_add_u32 s7, s7, 0
    s_and_b32 s7, s7, 15
    s_mul_i32 s7, s7, 114688
    s_add_u32 s7, s7, s67
    s_add_u32 m0, s68, 49152
    s_add_u32 s64, s7, 0
    buffer_load_dwordx4 v24, s[20:23], s64 offen lds
    s_add_u32 m0, s68, 50176
    s_add_u32 s64, s7, 0
    buffer_load_dwordx4 v25, s[20:23], s64 offen lds
    s_add_u32 m0, s68, 51200
    s_add_u32 s64, s7, 0
    buffer_load_dwordx4 v26, s[20:23], s64 offen lds
    s_add_u32 m0, s68, 52224
    s_add_u32 s64, s7, 0
    buffer_load_dwordx4 v27, s[20:23], s64 offen lds
    s_add_u32 m0, s68, 53248
    s_add_u32 s64, s7, 0
    buffer_load_dwordx4 v28, s[20:23], s64 offen lds
    s_add_u32 m0, s68, 54272
    s_add_u32 s64, s7, 0
    buffer_load_dwordx4 v29, s[20:23], s64 offen lds
    s_add_u32 m0, s68, 55296
    s_add_u32 s64, s7, 0
    buffer_load_dwordx4 v30, s[20:23], s64 offen lds
    s_add_u32 s7, s44, s5
    s_add_u32 s7, s7, 12
    s_and_b32 s7, s7, 15
    s_mul_i32 s7, s7, 114688
    s_add_u32 s7, s7, s67
    s_add_u32 m0, s68, 135168
    s_add_u32 s64, s7, 0
    buffer_load_dwordx4 v24, s[20:23], s64 offen lds
    s_add_u32 m0, s68, 136192
    s_add_u32 s64, s7, 0
    buffer_load_dwordx4 v25, s[20:23], s64 offen lds
    s_add_u32 m0, s68, 137216
    s_add_u32 s64, s7, 0
    buffer_load_dwordx4 v26, s[20:23], s64 offen lds
    s_add_u32 m0, s68, 138240
    s_add_u32 s64, s7, 0
    buffer_load_dwordx4 v27, s[20:23], s64 offen lds
    s_add_u32 m0, s68, 139264
    s_add_u32 s64, s7, 0
    buffer_load_dwordx4 v28, s[20:23], s64 offen lds
    s_add_u32 m0, s68, 140288
    s_add_u32 s64, s7, 0
    buffer_load_dwordx4 v29, s[20:23], s64 offen lds
    s_add_u32 m0, s68, 141312
    s_add_u32 s64, s7, 0
    buffer_load_dwordx4 v30, s[20:23], s64 offen lds
    v_and_b32 v4, 255, v0
    v_lshlrev_b32 v5, 7, v4
    s_mul_i32 s46, s4, 57344
    buffer_load_dword v31, v5, s[24:27], s46 offen
L_w1skip2:
    v_and_b32 v4, 255, v0
    v_lshrrev_b32 v5, 5, v4
    s_mov_b32 s46, 57344
    v_mul_lo_u32 v5, v5, s46
    v_and_b32 v4, 31, v4
    v_lshl_add_u32 v5, v4, 7, v5
    s_lshl_b32 s46, s40, 3
    s_mul_i32 s46, s46, 57344
    s_mul_i32 s47, s41, 7
    s_lshr_b32 s47, s47, 1
    s_lshl_b32 s47, s47, 10
    s_add_u32 s46, s46, s47
    s_add_u32 s46, s46, 4194304
    buffer_load_dword v31, v5, s[32:35], s46 offen
    v_lshrrev_b32 v4, 2, v2
    v_lshl_add_u32 v4, v3, 2, v4
    v_mul_u32_u24 v4, 224, v4
    v_and_b32 v5, 3, v1
    v_lshl_add_u32 v4, v5, 3, v4
    v_add_u32 v14, 49152, v4
    v_add_u32 v15, 113664, v4
    v_add_u32 v16, s68, v14
    v_add_u32 v17, 57344, v16
    s_waitcnt vmcnt(9)
    ds_read_b64_tr_b16 v[40:41], v16 offset:0
    ds_read_b64_tr_b16 v[42:43], v16 offset:3584
    ds_read_b64_tr_b16 v[44:45], v16 offset:32
    ds_read_b64_tr_b16 v[46:47], v16 offset:3616
    ds_read_b64_tr_b16 v[48:49], v16 offset:64
    ds_read_b64_tr_b16 v[50:51], v16 offset:3648
    ds_read_b64_tr_b16 v[52:53], v16 offset:96
    ds_read_b64_tr_b16 v[54:55], v16 offset:3680
    ds_read_b64_tr_b16 v[56:57], v16 offset:128
    ds_read_b64_tr_b16 v[58:59], v16 offset:3712
    ds_read_b64_tr_b16 v[60:61], v16 offset:160
    ds_read_b64_tr_b16 v[62:63], v16 offset:3744
    ds_read_b64_tr_b16 v[64:65], v16 offset:192
    ds_read_b64_tr_b16 v[66:67], v16 offset:3776
    s_waitcnt lgkmcnt(0)
    v_mfma_f32_16x16x32_bf16 v[164:167], v[40:43], v[10:13], 0
    v_mfma_f32_16x16x32_bf16 v[168:171], v[44:47], v[10:13], 0
    v_mfma_f32_16x16x32_bf16 v[172:175], v[48:51], v[10:13], 0
    v_mfma_f32_16x16x32_bf16 v[176:179], v[52:55], v[10:13], 0
    v_mfma_f32_16x16x32_bf16 v[180:183], v[56:59], v[10:13], 0
    v_mfma_f32_16x16x32_bf16 v[184:187], v[60:63], v[10:13], 0
    v_mfma_f32_16x16x32_bf16 v[188:191], v[64:67], v[10:13], 0
    s_waitcnt vmcnt(2)
    ds_read_b64_tr_b16 v[68:69], v17 offset:28672
    ds_read_b64_tr_b16 v[70:71], v17 offset:32256
    ds_read_b64_tr_b16 v[72:73], v17 offset:28704
    ds_read_b64_tr_b16 v[74:75], v17 offset:32288
    ds_read_b64_tr_b16 v[76:77], v17 offset:28736
    ds_read_b64_tr_b16 v[78:79], v17 offset:32320
    ds_read_b64_tr_b16 v[80:81], v17 offset:28768
    ds_read_b64_tr_b16 v[82:83], v17 offset:32352
    ds_read_b64_tr_b16 v[84:85], v17 offset:28800
    ds_read_b64_tr_b16 v[86:87], v17 offset:32384
    ds_read_b64_tr_b16 v[88:89], v17 offset:28832
    ds_read_b64_tr_b16 v[90:91], v17 offset:32416
    ds_read_b64_tr_b16 v[92:93], v17 offset:28864
    ds_read_b64_tr_b16 v[94:95], v17 offset:32448
    s_waitcnt lgkmcnt(0)
    v_mfma_f32_16x16x32_bf16 v[164:167], v[68:71], v[10:13], v[164:167]
    v_mfma_f32_16x16x32_bf16 v[168:171], v[72:75], v[10:13], v[168:171]
    v_mfma_f32_16x16x32_bf16 v[172:175], v[76:79], v[10:13], v[172:175]
    v_mfma_f32_16x16x32_bf16 v[176:179], v[80:83], v[10:13], v[176:179]
    v_mfma_f32_16x16x32_bf16 v[180:183], v[84:87], v[10:13], v[180:183]
    v_mfma_f32_16x16x32_bf16 v[184:187], v[88:91], v[10:13], v[184:187]
    v_mfma_f32_16x16x32_bf16 v[188:191], v[92:95], v[10:13], v[188:191]
    s_barrier
    v_and_b32 v4, 255, v0
    v_lshlrev_b32 v5, 7, v4
    s_mul_i32 s46, s4, 57344
    s_add_u32 s46, s46, 24576
    buffer_load_dword v31, v5, s[24:27], s46 offen
    ds_read_b64_tr_b16 v[68:69], v16 offset:28672
    ds_read_b64_tr_b16 v[70:71], v16 offset:32256
    ds_read_b64_tr_b16 v[72:73], v16 offset:28704
    ds_read_b64_tr_b16 v[74:75], v16 offset:32288
    ds_read_b64_tr_b16 v[76:77], v16 offset:28736
    ds_read_b64_tr_b16 v[78:79], v16 offset:32320
    ds_read_b64_tr_b16 v[80:81], v16 offset:28768
    ds_read_b64_tr_b16 v[82:83], v16 offset:32352
    ds_read_b64_tr_b16 v[84:85], v16 offset:28800
    ds_read_b64_tr_b16 v[86:87], v16 offset:32384
    ds_read_b64_tr_b16 v[88:89], v16 offset:28832
    ds_read_b64_tr_b16 v[90:91], v16 offset:32416
    ds_read_b64_tr_b16 v[92:93], v16 offset:28864
    ds_read_b64_tr_b16 v[94:95], v16 offset:32448
    s_waitcnt lgkmcnt(0)
    v_mfma_f32_16x16x32_bf16 v[164:167], v[68:71], v[10:13], v[164:167]
    v_mfma_f32_16x16x32_bf16 v[168:171], v[72:75], v[10:13], v[168:171]
    v_mfma_f32_16x16x32_bf16 v[172:175], v[76:79], v[10:13], v[172:175]
    v_mfma_f32_16x16x32_bf16 v[176:179], v[80:83], v[10:13], v[176:179]
    v_mfma_f32_16x16x32_bf16 v[180:183], v[84:87], v[10:13], v[180:183]
    v_mfma_f32_16x16x32_bf16 v[184:187], v[88:91], v[10:13], v[184:187]
    v_mfma_f32_16x16x32_bf16 v[188:191], v[92:95], v[10:13], v[188:191]
    ds_read_b64_tr_b16 v[40:41], v17 offset:0
    ds_read_b64_tr_b16 v[42:43], v17 offset:3584
    ds_read_b64_tr_b16 v[44:45], v17 offset:32
    ds_read_b64_tr_b16 v[46:47], v17 offset:3616
    ds_read_b64_tr_b16 v[48:49], v17 offset:64
    ds_read_b64_tr_b16 v[50:51], v17 offset:3648
    ds_read_b64_tr_b16 v[52:53], v17 offset:96
    ds_read_b64_tr_b16 v[54:55], v17 offset:3680
    ds_read_b64_tr_b16 v[56:57], v17 offset:128
    ds_read_b64_tr_b16 v[58:59], v17 offset:3712
    ds_read_b64_tr_b16 v[60:61], v17 offset:160
    ds_read_b64_tr_b16 v[62:63], v17 offset:3744
    ds_read_b64_tr_b16 v[64:65], v17 offset:192
    ds_read_b64_tr_b16 v[66:67], v17 offset:3776
    s_waitcnt lgkmcnt(0)
    v_mfma_f32_16x16x32_bf16 v[164:167], v[40:43], v[10:13], v[164:167]
    v_mfma_f32_16x16x32_bf16 v[168:171], v[44:47], v[10:13], v[168:171]
    v_mfma_f32_16x16x32_bf16 v[172:175], v[48:51], v[10:13], v[172:175]
    v_mfma_f32_16x16x32_bf16 v[176:179], v[52:55], v[10:13], v[176:179]
    v_mfma_f32_16x16x32_bf16 v[180:183], v[56:59], v[10:13], v[180:183]
    v_mfma_f32_16x16x32_bf16 v[184:187], v[60:63], v[10:13], v[184:187]
    v_mfma_f32_16x16x32_bf16 v[188:191], v[64:67], v[10:13], v[188:191]
    s_barrier
    s_mul_i32 s46, s44, 448
    s_add_u32 s46, s46, 40960
    v_lshlrev_b32 v4, 4, v3
    v_add_u32 v5, s46, v4
    v_add_u32 v6, 40960, v4
    ds_write_b128 v5, v[164:167] offset:0
    ds_write_b128 v5, v[168:171] offset:64
    ds_write_b128 v5, v[172:175] offset:128
    ds_write_b128 v5, v[176:179] offset:192
    ds_write_b128 v5, v[180:183] offset:256
    ds_write_b128 v5, v[184:187] offset:320
    ds_write_b128 v5, v[188:191] offset:384
    s_waitcnt lgkmcnt(0) vmcnt(0)
    s_barrier
    ds_read_b128 v[164:167], v6 offset:0
    ds_read_b128 v[168:171], v6 offset:64
    ds_read_b128 v[172:175], v6 offset:128
    ds_read_b128 v[176:179], v6 offset:192
    ds_read_b128 v[180:183], v6 offset:256
    ds_read_b128 v[184:187], v6 offset:320
    ds_read_b128 v[188:191], v6 offset:384
    s_waitcnt lgkmcnt(0)
    ds_read_b128 v[192:195], v6 offset:448
    ds_read_b128 v[196:199], v6 offset:512
    ds_read_b128 v[200:203], v6 offset:576
    ds_read_b128 v[204:207], v6 offset:640
    ds_read_b128 v[208:211], v6 offset:704
    ds_read_b128 v[212:215], v6 offset:768
    ds_read_b128 v[216:219], v6 offset:832
    s_waitcnt lgkmcnt(0)
    v_add_f32 v164, v164, v192
    v_add_f32 v165, v165, v193
    v_add_f32 v166, v166, v194
    v_add_f32 v167, v167, v195
    v_add_f32 v168, v168, v196
    v_add_f32 v169, v169, v197
    v_add_f32 v170, v170, v198
    v_add_f32 v171, v171, v199
    v_add_f32 v172, v172, v200
    v_add_f32 v173, v173, v201
    v_add_f32 v174, v174, v202
    v_add_f32 v175, v175, v203
    v_add_f32 v176, v176, v204
    v_add_f32 v177, v177, v205
    v_add_f32 v178, v178, v206
    v_add_f32 v179, v179, v207
    v_add_f32 v180, v180, v208
    v_add_f32 v181, v181, v209
    v_add_f32 v182, v182, v210
    v_add_f32 v183, v183, v211
    v_add_f32 v184, v184, v212
    v_add_f32 v185, v185, v213
    v_add_f32 v186, v186, v214
    v_add_f32 v187, v187, v215
    v_add_f32 v188, v188, v216
    v_add_f32 v189, v189, v217
    v_add_f32 v190, v190, v218
    v_add_f32 v191, v191, v219
    ds_read_b128 v[192:195], v6 offset:896
    ds_read_b128 v[196:199], v6 offset:960
    ds_read_b128 v[200:203], v6 offset:1024
    ds_read_b128 v[204:207], v6 offset:1088
    ds_read_b128 v[208:211], v6 offset:1152
    ds_read_b128 v[212:215], v6 offset:1216
    ds_read_b128 v[216:219], v6 offset:1280
    s_waitcnt lgkmcnt(0)
    v_add_f32 v164, v164, v192
    v_add_f32 v165, v165, v193
    v_add_f32 v166, v166, v194
    v_add_f32 v167, v167, v195
    v_add_f32 v168, v168, v196
    v_add_f32 v169, v169, v197
    v_add_f32 v170, v170, v198
    v_add_f32 v171, v171, v199
    v_add_f32 v172, v172, v200
    v_add_f32 v173, v173, v201
    v_add_f32 v174, v174, v202
    v_add_f32 v175, v175, v203
    v_add_f32 v176, v176, v204
    v_add_f32 v177, v177, v205
    v_add_f32 v178, v178, v206
    v_add_f32 v179, v179, v207
    v_add_f32 v180, v180, v208
    v_add_f32 v181, v181, v209
    v_add_f32 v182, v182, v210
    v_add_f32 v183, v183, v211
    v_add_f32 v184, v184, v212
    v_add_f32 v185, v185, v213
    v_add_f32 v186, v186, v214
    v_add_f32 v187, v187, v215
    v_add_f32 v188, v188, v216
    v_add_f32 v189, v189, v217
    v_add_f32 v190, v190, v218
    v_add_f32 v191, v191, v219
    ds_read_b128 v[192:195], v6 offset:1344
    ds_read_b128 v[196:199], v6 offset:1408
    ds_read_b128 v[200:203], v6 offset:1472
    ds_read_b128 v[204:207], v6 offset:1536
    ds_read_b128 v[208:211], v6 offset:1600
    ds_read_b128 v[212:215], v6 offset:1664
    ds_read_b128 v[216:219], v6 offset:1728
    s_waitcnt lgkmcnt(0)
    v_add_f32 v164, v164, v192
    v_add_f32 v165, v165, v193
    v_add_f32 v166, v166, v194
    v_add_f32 v167, v167, v195
    v_add_f32 v168, v168, v196
    v_add_f32 v169, v169, v197
    v_add_f32 v170, v170, v198
    v_add_f32 v171, v171, v199
    v_add_f32 v172, v172, v200
    v_add_f32 v173, v173, v201
    v_add_f32 v174, v174, v202
    v_add_f32 v175, v175, v203
    v_add_f32 v176, v176, v204
    v_add_f32 v177, v177, v205
    v_add_f32 v178, v178, v206
    v_add_f32 v179, v179, v207
    v_add_f32 v180, v180, v208
    v_add_f32 v181, v181, v209
    v_add_f32 v182, v182, v210
    v_add_f32 v183, v183, v211
    v_add_f32 v184, v184, v212
    v_add_f32 v185, v185, v213
    v_add_f32 v186, v186, v214
    v_add_f32 v187, v187, v215
    v_add_f32 v188, v188, v216
    v_add_f32 v189, v189, v217
    v_add_f32 v190, v190, v218
    v_add_f32 v191, v191, v219
    s_lshl_b32 s46, s44, 11
    v_add_u32 v18, s46, v7
    s_barrier
    s_lshl_b32 s46, s40, 3
    s_lshl_b32 s47, s44, 1
    s_add_u32 s46, s46, s47
    s_mov_b32 s54, s46
    s_lshl_b32 s49, s46, 10
    s_add_u32 s49, s49, 12582912
    buffer_load_dwordx4 v[240:243], v7, s[32:35], s49 offen sc1
    buffer_load_dwordx4 v[244:247], v7, s[32:35], s49 offen offset:1024 sc1
    ds_read_b128 v[24:27], v18 offset:0
    ds_read_b128 v[28:31], v18 offset:1024
    ds_read_b64_tr_b16 v[40:41], v14 offset:0
    ds_read_b64_tr_b16 v[42:43], v14 offset:3584
    ds_read_b64_tr_b16 v[44:45], v14 offset:32
    ds_read_b64_tr_b16 v[46:47], v14 offset:3616
    ds_read_b64_tr_b16 v[48:49], v14 offset:64
    ds_read_b64_tr_b16 v[50:51], v14 offset:3648
    ds_read_b64_tr_b16 v[52:53], v14 offset:96
    ds_read_b64_tr_b16 v[54:55], v14 offset:3680
    ds_read_b64_tr_b16 v[56:57], v14 offset:128
    ds_read_b64_tr_b16 v[58:59], v14 offset:3712
    ds_read_b64_tr_b16 v[60:61], v14 offset:160
    ds_read_b64_tr_b16 v[62:63], v14 offset:3744
    ds_read_b64_tr_b16 v[64:65], v14 offset:192
    ds_read_b64_tr_b16 v[66:67], v14 offset:3776
    s_waitcnt lgkmcnt(0)
    v_mfma_f32_16x16x32_bf16 v[96:99], v[40:43], v[24:27], 0
    ds_read_b128 v[32:35], v18 offset:8192
    ds_read_b128 v[36:39], v18 offset:9216
    v_mfma_f32_16x16x32_bf16 v[124:127], v[40:43], v[28:31], 0
    ds_read_b64_tr_b16 v[68:69], v14 offset:7168
    v_mfma_f32_16x16x32_bf16 v[100:103], v[44:47], v[24:27], 0
    ds_read_b64_tr_b16 v[70:71], v14 offset:10752
    v_mfma_f32_16x16x32_bf16 v[128:131], v[44:47], v[28:31], 0
    ds_read_b64_tr_b16 v[72:73], v14 offset:7200
    v_mfma_f32_16x16x32_bf16 v[104:107], v[48:51], v[24:27], 0
    ds_read_b64_tr_b16 v[74:75], v14 offset:10784
    v_mfma_f32_16x16x32_bf16 v[132:135], v[48:51], v[28:31], 0
    ds_read_b64_tr_b16 v[76:77], v14 offset:7232
    v_mfma_f32_16x16x32_bf16 v[108:111], v[52:55], v[24:27], 0
    ds_read_b64_tr_b16 v[78:79], v14 offset:10816
    v_mfma_f32_16x16x32_bf16 v[136:139], v[52:55], v[28:31], 0
    ds_read_b64_tr_b16 v[80:81], v14 offset:7264
    ds_read_b64_tr_b16 v[82:83], v14 offset:10848
    v_mfma_f32_16x16x32_bf16 v[112:115], v[56:59], v[24:27], 0
    ds_read_b64_tr_b16 v[84:85], v14 offset:7296
    v_mfma_f32_16x16x32_bf16 v[140:143], v[56:59], v[28:31], 0
    ds_read_b64_tr_b16 v[86:87], v14 offset:10880
    v_mfma_f32_16x16x32_bf16 v[116:119], v[60:63], v[24:27], 0
    ds_read_b64_tr_b16 v[88:89], v14 offset:7328
    v_mfma_f32_16x16x32_bf16 v[144:147], v[60:63], v[28:31], 0
    ds_read_b64_tr_b16 v[90:91], v14 offset:10912
    v_mfma_f32_16x16x32_bf16 v[120:123], v[64:67], v[24:27], 0
    ds_read_b64_tr_b16 v[92:93], v14 offset:7360
    v_mfma_f32_16x16x32_bf16 v[148:151], v[64:67], v[28:31], 0
    ds_read_b64_tr_b16 v[94:95], v14 offset:10944
    s_waitcnt lgkmcnt(0)
    s_barrier
    v_mfma_f32_16x16x32_bf16 v[96:99], v[68:71], v[32:35], v[96:99]
    ds_read_b128 v[24:27], v18 offset:16384
    ds_read_b128 v[28:31], v18 offset:17408
    v_mfma_f32_16x16x32_bf16 v[124:127], v[68:71], v[36:39], v[124:127]
    ds_read_b64_tr_b16 v[40:41], v14 offset:14336
    v_mfma_f32_16x16x32_bf16 v[100:103], v[72:75], v[32:35], v[100:103]
    ds_read_b64_tr_b16 v[42:43], v14 offset:17920
    v_mfma_f32_16x16x32_bf16 v[128:131], v[72:75], v[36:39], v[128:131]
    ds_read_b64_tr_b16 v[44:45], v14 offset:14368
    v_mfma_f32_16x16x32_bf16 v[104:107], v[76:79], v[32:35], v[104:107]
    ds_read_b64_tr_b16 v[46:47], v14 offset:17952
    v_mfma_f32_16x16x32_bf16 v[132:135], v[76:79], v[36:39], v[132:135]
    ds_read_b64_tr_b16 v[48:49], v14 offset:14400
    v_mfma_f32_16x16x32_bf16 v[108:111], v[80:83], v[32:35], v[108:111]
    ds_read_b64_tr_b16 v[50:51], v14 offset:17984
    v_mfma_f32_16x16x32_bf16 v[136:139], v[80:83], v[36:39], v[136:139]
    ds_read_b64_tr_b16 v[52:53], v14 offset:14432
    ds_read_b64_tr_b16 v[54:55], v14 offset:18016
    v_mfma_f32_16x16x32_bf16 v[112:115], v[84:87], v[32:35], v[112:115]
    ds_read_b64_tr_b16 v[56:57], v14 offset:14464
    v_mfma_f32_16x16x32_bf16 v[140:143], v[84:87], v[36:39], v[140:143]
    ds_read_b64_tr_b16 v[58:59], v14 offset:18048
    v_mfma_f32_16x16x32_bf16 v[116:119], v[88:91], v[32:35], v[116:119]
    ds_read_b64_tr_b16 v[60:61], v14 offset:14496
    v_mfma_f32_16x16x32_bf16 v[144:147], v[88:91], v[36:39], v[144:147]
    ds_read_b64_tr_b16 v[62:63], v14 offset:18080
    v_mfma_f32_16x16x32_bf16 v[120:123], v[92:95], v[32:35], v[120:123]
    ds_read_b64_tr_b16 v[64:65], v14 offset:14528
    v_mfma_f32_16x16x32_bf16 v[148:151], v[92:95], v[36:39], v[148:151]
    ds_read_b64_tr_b16 v[66:67], v14 offset:18112
    s_waitcnt lgkmcnt(0)
    v_mfma_f32_16x16x32_bf16 v[96:99], v[40:43], v[24:27], v[96:99]
    ds_read_b128 v[32:35], v18 offset:24576
    ds_read_b128 v[36:39], v18 offset:25600
    v_mfma_f32_16x16x32_bf16 v[124:127], v[40:43], v[28:31], v[124:127]
    ds_read_b64_tr_b16 v[68:69], v14 offset:21504
    v_mfma_f32_16x16x32_bf16 v[100:103], v[44:47], v[24:27], v[100:103]
    ds_read_b64_tr_b16 v[70:71], v14 offset:25088
    v_mfma_f32_16x16x32_bf16 v[128:131], v[44:47], v[28:31], v[128:131]
    ds_read_b64_tr_b16 v[72:73], v14 offset:21536
    v_mfma_f32_16x16x32_bf16 v[104:107], v[48:51], v[24:27], v[104:107]
    ds_read_b64_tr_b16 v[74:75], v14 offset:25120
    v_mfma_f32_16x16x32_bf16 v[132:135], v[48:51], v[28:31], v[132:135]
    ds_read_b64_tr_b16 v[76:77], v14 offset:21568
    v_mfma_f32_16x16x32_bf16 v[108:111], v[52:55], v[24:27], v[108:111]
    ds_read_b64_tr_b16 v[78:79], v14 offset:25152
    v_mfma_f32_16x16x32_bf16 v[136:139], v[52:55], v[28:31], v[136:139]
    ds_read_b64_tr_b16 v[80:81], v14 offset:21600
    ds_read_b64_tr_b16 v[82:83], v14 offset:25184
    v_mfma_f32_16x16x32_bf16 v[112:115], v[56:59], v[24:27], v[112:115]
    ds_read_b64_tr_b16 v[84:85], v14 offset:21632
    v_mfma_f32_16x16x32_bf16 v[140:143], v[56:59], v[28:31], v[140:143]
    ds_read_b64_tr_b16 v[86:87], v14 offset:25216
    v_mfma_f32_16x16x32_bf16 v[116:119], v[60:63], v[24:27], v[116:119]
    ds_read_b64_tr_b16 v[88:89], v14 offset:21664
    v_mfma_f32_16x16x32_bf16 v[144:147], v[60:63], v[28:31], v[144:147]
    ds_read_b64_tr_b16 v[90:91], v14 offset:25248
    v_mfma_f32_16x16x32_bf16 v[120:123], v[64:67], v[24:27], v[120:123]
    ds_read_b64_tr_b16 v[92:93], v14 offset:21696
    v_mfma_f32_16x16x32_bf16 v[148:151], v[64:67], v[28:31], v[148:151]
    ds_read_b64_tr_b16 v[94:95], v14 offset:25280
    s_waitcnt lgkmcnt(0)
    s_barrier
    v_mfma_f32_16x16x32_bf16 v[96:99], v[68:71], v[32:35], v[96:99]
    ds_read_b128 v[24:27], v18 offset:32768
    ds_read_b128 v[28:31], v18 offset:33792
    v_mfma_f32_16x16x32_bf16 v[124:127], v[68:71], v[36:39], v[124:127]
    ds_read_b64_tr_b16 v[40:41], v14 offset:28672
    v_mfma_f32_16x16x32_bf16 v[100:103], v[72:75], v[32:35], v[100:103]
    ds_read_b64_tr_b16 v[42:43], v14 offset:32256
    v_mfma_f32_16x16x32_bf16 v[128:131], v[72:75], v[36:39], v[128:131]
    ds_read_b64_tr_b16 v[44:45], v14 offset:28704
    v_mfma_f32_16x16x32_bf16 v[104:107], v[76:79], v[32:35], v[104:107]
    ds_read_b64_tr_b16 v[46:47], v14 offset:32288
    v_mfma_f32_16x16x32_bf16 v[132:135], v[76:79], v[36:39], v[132:135]
    ds_read_b64_tr_b16 v[48:49], v14 offset:28736
    v_mfma_f32_16x16x32_bf16 v[108:111], v[80:83], v[32:35], v[108:111]
    ds_read_b64_tr_b16 v[50:51], v14 offset:32320
    v_mfma_f32_16x16x32_bf16 v[136:139], v[80:83], v[36:39], v[136:139]
    ds_read_b64_tr_b16 v[52:53], v14 offset:28768
    ds_read_b64_tr_b16 v[54:55], v14 offset:32352
    v_mfma_f32_16x16x32_bf16 v[112:115], v[84:87], v[32:35], v[112:115]
    ds_read_b64_tr_b16 v[56:57], v14 offset:28800
    v_mfma_f32_16x16x32_bf16 v[140:143], v[84:87], v[36:39], v[140:143]
    ds_read_b64_tr_b16 v[58:59], v14 offset:32384
    v_mfma_f32_16x16x32_bf16 v[116:119], v[88:91], v[32:35], v[116:119]
    ds_read_b64_tr_b16 v[60:61], v14 offset:28832
    v_mfma_f32_16x16x32_bf16 v[144:147], v[88:91], v[36:39], v[144:147]
    ds_read_b64_tr_b16 v[62:63], v14 offset:32416
    v_mfma_f32_16x16x32_bf16 v[120:123], v[92:95], v[32:35], v[120:123]
    ds_read_b64_tr_b16 v[64:65], v14 offset:28864
    v_mfma_f32_16x16x32_bf16 v[148:151], v[92:95], v[36:39], v[148:151]
    ds_read_b64_tr_b16 v[66:67], v14 offset:32448
    s_waitcnt lgkmcnt(0)
    v_mfma_f32_16x16x32_bf16 v[96:99], v[40:43], v[24:27], v[96:99]
    ds_read_b128 v[32:35], v18 offset:40960
    ds_read_b128 v[36:39], v18 offset:41984
    v_mfma_f32_16x16x32_bf16 v[124:127], v[40:43], v[28:31], v[124:127]
    ds_read_b64_tr_b16 v[68:69], v14 offset:35840
    v_mfma_f32_16x16x32_bf16 v[100:103], v[44:47], v[24:27], v[100:103]
    ds_read_b64_tr_b16 v[70:71], v14 offset:39424
    v_mfma_f32_16x16x32_bf16 v[128:131], v[44:47], v[28:31], v[128:131]
    ds_read_b64_tr_b16 v[72:73], v14 offset:35872
    v_mfma_f32_16x16x32_bf16 v[104:107], v[48:51], v[24:27], v[104:107]
    ds_read_b64_tr_b16 v[74:75], v14 offset:39456
    v_mfma_f32_16x16x32_bf16 v[132:135], v[48:51], v[28:31], v[132:135]
    ds_read_b64_tr_b16 v[76:77], v14 offset:35904
    v_mfma_f32_16x16x32_bf16 v[108:111], v[52:55], v[24:27], v[108:111]
    ds_read_b64_tr_b16 v[78:79], v14 offset:39488
    v_mfma_f32_16x16x32_bf16 v[136:139], v[52:55], v[28:31], v[136:139]
    ds_read_b64_tr_b16 v[80:81], v14 offset:35936
    ds_read_b64_tr_b16 v[82:83], v14 offset:39520
    v_mfma_f32_16x16x32_bf16 v[112:115], v[56:59], v[24:27], v[112:115]
    ds_read_b64_tr_b16 v[84:85], v14 offset:35968
    v_mfma_f32_16x16x32_bf16 v[140:143], v[56:59], v[28:31], v[140:143]
    ds_read_b64_tr_b16 v[86:87], v14 offset:39552
    v_mfma_f32_16x16x32_bf16 v[116:119], v[60:63], v[24:27], v[116:119]
    ds_read_b64_tr_b16 v[88:89], v14 offset:36000
    v_mfma_f32_16x16x32_bf16 v[144:147], v[60:63], v[28:31], v[144:147]
    ds_read_b64_tr_b16 v[90:91], v14 offset:39584
    v_mfma_f32_16x16x32_bf16 v[120:123], v[64:67], v[24:27], v[120:123]
    ds_read_b64_tr_b16 v[92:93], v14 offset:36032
    v_mfma_f32_16x16x32_bf16 v[148:151], v[64:67], v[28:31], v[148:151]
    ds_read_b64_tr_b16 v[94:95], v14 offset:39616
    s_waitcnt lgkmcnt(0)
    s_barrier
    v_mfma_f32_16x16x32_bf16 v[96:99], v[68:71], v[32:35], v[96:99]
    ds_read_b128 v[24:27], v18 offset:0
    ds_read_b128 v[28:31], v18 offset:1024
    v_mfma_f32_16x16x32_bf16 v[124:127], v[68:71], v[36:39], v[124:127]
    ds_read_b64_tr_b16 v[40:41], v14 offset:43008
    v_mfma_f32_16x16x32_bf16 v[100:103], v[72:75], v[32:35], v[100:103]
    ds_read_b64_tr_b16 v[42:43], v14 offset:46592
    v_mfma_f32_16x16x32_bf16 v[128:131], v[72:75], v[36:39], v[128:131]
    ds_read_b64_tr_b16 v[44:45], v14 offset:43040
    v_mfma_f32_16x16x32_bf16 v[104:107], v[76:79], v[32:35], v[104:107]
    ds_read_b64_tr_b16 v[46:47], v14 offset:46624
    v_mfma_f32_16x16x32_bf16 v[132:135], v[76:79], v[36:39], v[132:135]
    ds_read_b64_tr_b16 v[48:49], v14 offset:43072
    v_mfma_f32_16x16x32_bf16 v[108:111], v[80:83], v[32:35], v[108:111]
    ds_read_b64_tr_b16 v[50:51], v14 offset:46656
    v_mfma_f32_16x16x32_bf16 v[136:139], v[80:83], v[36:39], v[136:139]
    ds_read_b64_tr_b16 v[52:53], v14 offset:43104
    ds_read_b64_tr_b16 v[54:55], v14 offset:46688
    v_mfma_f32_16x16x32_bf16 v[112:115], v[84:87], v[32:35], v[112:115]
    ds_read_b64_tr_b16 v[56:57], v14 offset:43136
    v_mfma_f32_16x16x32_bf16 v[140:143], v[84:87], v[36:39], v[140:143]
    ds_read_b64_tr_b16 v[58:59], v14 offset:46720
    v_mfma_f32_16x16x32_bf16 v[116:119], v[88:91], v[32:35], v[116:119]
    ds_read_b64_tr_b16 v[60:61], v14 offset:43168
    v_mfma_f32_16x16x32_bf16 v[144:147], v[88:91], v[36:39], v[144:147]
    ds_read_b64_tr_b16 v[62:63], v14 offset:46752
    v_mfma_f32_16x16x32_bf16 v[120:123], v[92:95], v[32:35], v[120:123]
    ds_read_b64_tr_b16 v[64:65], v14 offset:43200
    v_mfma_f32_16x16x32_bf16 v[148:151], v[92:95], v[36:39], v[148:151]
    ds_read_b64_tr_b16 v[66:67], v14 offset:46784
    s_waitcnt lgkmcnt(0)
    v_mfma_f32_16x16x32_bf16 v[96:99], v[40:43], v[24:27], v[96:99]
    ds_read_b128 v[32:35], v18 offset:8192
    ds_read_b128 v[36:39], v18 offset:9216
    v_mfma_f32_16x16x32_bf16 v[124:127], v[40:43], v[28:31], v[124:127]
    ds_read_b64_tr_b16 v[68:69], v14 offset:50176
    v_mfma_f32_16x16x32_bf16 v[100:103], v[44:47], v[24:27], v[100:103]
    ds_read_b64_tr_b16 v[70:71], v14 offset:53760
    v_mfma_f32_16x16x32_bf16 v[128:131], v[44:47], v[28:31], v[128:131]
    ds_read_b64_tr_b16 v[72:73], v14 offset:50208
    v_mfma_f32_16x16x32_bf16 v[104:107], v[48:51], v[24:27], v[104:107]
    ds_read_b64_tr_b16 v[74:75], v14 offset:53792
    v_mfma_f32_16x16x32_bf16 v[132:135], v[48:51], v[28:31], v[132:135]
    ds_read_b64_tr_b16 v[76:77], v14 offset:50240
    v_mfma_f32_16x16x32_bf16 v[108:111], v[52:55], v[24:27], v[108:111]
    ds_read_b64_tr_b16 v[78:79], v14 offset:53824
    v_mfma_f32_16x16x32_bf16 v[136:139], v[52:55], v[28:31], v[136:139]
    ds_read_b64_tr_b16 v[80:81], v14 offset:50272
    ds_read_b64_tr_b16 v[82:83], v14 offset:53856
    v_mfma_f32_16x16x32_bf16 v[112:115], v[56:59], v[24:27], v[112:115]
    ds_read_b64_tr_b16 v[84:85], v14 offset:50304
    v_mfma_f32_16x16x32_bf16 v[140:143], v[56:59], v[28:31], v[140:143]
    ds_read_b64_tr_b16 v[86:87], v14 offset:53888
    v_mfma_f32_16x16x32_bf16 v[116:119], v[60:63], v[24:27], v[116:119]
    ds_read_b64_tr_b16 v[88:89], v14 offset:50336
    v_mfma_f32_16x16x32_bf16 v[144:147], v[60:63], v[28:31], v[144:147]
    ds_read_b64_tr_b16 v[90:91], v14 offset:53920
    v_mfma_f32_16x16x32_bf16 v[120:123], v[64:67], v[24:27], v[120:123]
    ds_read_b64_tr_b16 v[92:93], v14 offset:50368
    v_mfma_f32_16x16x32_bf16 v[148:151], v[64:67], v[28:31], v[148:151]
    ds_read_b64_tr_b16 v[94:95], v14 offset:53952
    s_waitcnt lgkmcnt(0)
    s_barrier
    v_mfma_f32_16x16x32_bf16 v[96:99], v[68:71], v[32:35], v[96:99]
    ds_read_b128 v[24:27], v18 offset:16384
    ds_read_b128 v[28:31], v18 offset:17408
    v_mfma_f32_16x16x32_bf16 v[124:127], v[68:71], v[36:39], v[124:127]
    ds_read_b64_tr_b16 v[40:41], v14 offset:57344
    v_mfma_f32_16x16x32_bf16 v[100:103], v[72:75], v[32:35], v[100:103]
    ds_read_b64_tr_b16 v[42:43], v14 offset:60928
    v_mfma_f32_16x16x32_bf16 v[128:131], v[72:75], v[36:39], v[128:131]
    ds_read_b64_tr_b16 v[44:45], v14 offset:57376
    v_mfma_f32_16x16x32_bf16 v[104:107], v[76:79], v[32:35], v[104:107]
    ds_read_b64_tr_b16 v[46:47], v14 offset:60960
    v_mfma_f32_16x16x32_bf16 v[132:135], v[76:79], v[36:39], v[132:135]
    ds_read_b64_tr_b16 v[48:49], v14 offset:57408
    v_mfma_f32_16x16x32_bf16 v[108:111], v[80:83], v[32:35], v[108:111]
    ds_read_b64_tr_b16 v[50:51], v14 offset:60992
    v_mfma_f32_16x16x32_bf16 v[136:139], v[80:83], v[36:39], v[136:139]
    ds_read_b64_tr_b16 v[52:53], v14 offset:57440
    ds_read_b64_tr_b16 v[54:55], v14 offset:61024
    v_mfma_f32_16x16x32_bf16 v[112:115], v[84:87], v[32:35], v[112:115]
    ds_read_b64_tr_b16 v[56:57], v14 offset:57472
    v_mfma_f32_16x16x32_bf16 v[140:143], v[84:87], v[36:39], v[140:143]
    ds_read_b64_tr_b16 v[58:59], v14 offset:61056
    v_mfma_f32_16x16x32_bf16 v[116:119], v[88:91], v[32:35], v[116:119]
    ds_read_b64_tr_b16 v[60:61], v14 offset:57504
    v_mfma_f32_16x16x32_bf16 v[144:147], v[88:91], v[36:39], v[144:147]
    ds_read_b64_tr_b16 v[62:63], v14 offset:61088
    v_mfma_f32_16x16x32_bf16 v[120:123], v[92:95], v[32:35], v[120:123]
    ds_read_b64_tr_b16 v[64:65], v14 offset:57536
    v_mfma_f32_16x16x32_bf16 v[148:151], v[92:95], v[36:39], v[148:151]
    ds_read_b64_tr_b16 v[66:67], v14 offset:61120
    s_waitcnt lgkmcnt(0)
    v_mfma_f32_16x16x32_bf16 v[96:99], v[40:43], v[24:27], v[96:99]
    ds_read_b128 v[32:35], v18 offset:24576
    ds_read_b128 v[36:39], v18 offset:25600
    v_mfma_f32_16x16x32_bf16 v[124:127], v[40:43], v[28:31], v[124:127]
    ds_read_b64_tr_b16 v[68:69], v15 offset:0
    v_mfma_f32_16x16x32_bf16 v[100:103], v[44:47], v[24:27], v[100:103]
    ds_read_b64_tr_b16 v[70:71], v15 offset:3584
    v_mfma_f32_16x16x32_bf16 v[128:131], v[44:47], v[28:31], v[128:131]
    ds_read_b64_tr_b16 v[72:73], v15 offset:32
    v_mfma_f32_16x16x32_bf16 v[104:107], v[48:51], v[24:27], v[104:107]
    ds_read_b64_tr_b16 v[74:75], v15 offset:3616
    v_mfma_f32_16x16x32_bf16 v[132:135], v[48:51], v[28:31], v[132:135]
    ds_read_b64_tr_b16 v[76:77], v15 offset:64
    v_mfma_f32_16x16x32_bf16 v[108:111], v[52:55], v[24:27], v[108:111]
    ds_read_b64_tr_b16 v[78:79], v15 offset:3648
    v_mfma_f32_16x16x32_bf16 v[136:139], v[52:55], v[28:31], v[136:139]
    ds_read_b64_tr_b16 v[80:81], v15 offset:96
    ds_read_b64_tr_b16 v[82:83], v15 offset:3680
    v_mfma_f32_16x16x32_bf16 v[112:115], v[56:59], v[24:27], v[112:115]
    ds_read_b64_tr_b16 v[84:85], v15 offset:128
    v_mfma_f32_16x16x32_bf16 v[140:143], v[56:59], v[28:31], v[140:143]
    ds_read_b64_tr_b16 v[86:87], v15 offset:3712
    v_mfma_f32_16x16x32_bf16 v[116:119], v[60:63], v[24:27], v[116:119]
    ds_read_b64_tr_b16 v[88:89], v15 offset:160
    v_mfma_f32_16x16x32_bf16 v[144:147], v[60:63], v[28:31], v[144:147]
    ds_read_b64_tr_b16 v[90:91], v15 offset:3744
    v_mfma_f32_16x16x32_bf16 v[120:123], v[64:67], v[24:27], v[120:123]
    ds_read_b64_tr_b16 v[92:93], v15 offset:192
    v_mfma_f32_16x16x32_bf16 v[148:151], v[64:67], v[28:31], v[148:151]
    ds_read_b64_tr_b16 v[94:95], v15 offset:3776
    s_waitcnt lgkmcnt(0)
    s_barrier
    v_mfma_f32_16x16x32_bf16 v[96:99], v[68:71], v[32:35], v[96:99]
    ds_read_b128 v[24:27], v18 offset:32768
    ds_read_b128 v[28:31], v18 offset:33792
    v_mfma_f32_16x16x32_bf16 v[124:127], v[68:71], v[36:39], v[124:127]
    ds_read_b64_tr_b16 v[40:41], v15 offset:7168
    v_mfma_f32_16x16x32_bf16 v[100:103], v[72:75], v[32:35], v[100:103]
    ds_read_b64_tr_b16 v[42:43], v15 offset:10752
    v_mfma_f32_16x16x32_bf16 v[128:131], v[72:75], v[36:39], v[128:131]
    ds_read_b64_tr_b16 v[44:45], v15 offset:7200
    v_mfma_f32_16x16x32_bf16 v[104:107], v[76:79], v[32:35], v[104:107]
    ds_read_b64_tr_b16 v[46:47], v15 offset:10784
    v_mfma_f32_16x16x32_bf16 v[132:135], v[76:79], v[36:39], v[132:135]
    ds_read_b64_tr_b16 v[48:49], v15 offset:7232
    v_mfma_f32_16x16x32_bf16 v[108:111], v[80:83], v[32:35], v[108:111]
    ds_read_b64_tr_b16 v[50:51], v15 offset:10816
    v_mfma_f32_16x16x32_bf16 v[136:139], v[80:83], v[36:39], v[136:139]
    ds_read_b64_tr_b16 v[52:53], v15 offset:7264
    ds_read_b64_tr_b16 v[54:55], v15 offset:10848
    v_mfma_f32_16x16x32_bf16 v[112:115], v[84:87], v[32:35], v[112:115]
    ds_read_b64_tr_b16 v[56:57], v15 offset:7296
    v_mfma_f32_16x16x32_bf16 v[140:143], v[84:87], v[36:39], v[140:143]
    ds_read_b64_tr_b16 v[58:59], v15 offset:10880
    v_mfma_f32_16x16x32_bf16 v[116:119], v[88:91], v[32:35], v[116:119]
    ds_read_b64_tr_b16 v[60:61], v15 offset:7328
    v_mfma_f32_16x16x32_bf16 v[144:147], v[88:91], v[36:39], v[144:147]
    ds_read_b64_tr_b16 v[62:63], v15 offset:10912
    v_mfma_f32_16x16x32_bf16 v[120:123], v[92:95], v[32:35], v[120:123]
    ds_read_b64_tr_b16 v[64:65], v15 offset:7360
    v_mfma_f32_16x16x32_bf16 v[148:151], v[92:95], v[36:39], v[148:151]
    ds_read_b64_tr_b16 v[66:67], v15 offset:10944
    s_waitcnt lgkmcnt(0)
    v_mfma_f32_16x16x32_bf16 v[96:99], v[40:43], v[24:27], v[96:99]
    ds_read_b128 v[32:35], v18 offset:40960
    ds_read_b128 v[36:39], v18 offset:41984
    v_mfma_f32_16x16x32_bf16 v[124:127], v[40:43], v[28:31], v[124:127]
    ds_read_b64_tr_b16 v[68:69], v15 offset:14336
    v_mfma_f32_16x16x32_bf16 v[100:103], v[44:47], v[24:27], v[100:103]
    ds_read_b64_tr_b16 v[70:71], v15 offset:17920
    v_mfma_f32_16x16x32_bf16 v[128:131], v[44:47], v[28:31], v[128:131]
    ds_read_b64_tr_b16 v[72:73], v15 offset:14368
    v_mfma_f32_16x16x32_bf16 v[104:107], v[48:51], v[24:27], v[104:107]
    ds_read_b64_tr_b16 v[74:75], v15 offset:17952
    v_mfma_f32_16x16x32_bf16 v[132:135], v[48:51], v[28:31], v[132:135]
    ds_read_b64_tr_b16 v[76:77], v15 offset:14400
    v_mfma_f32_16x16x32_bf16 v[108:111], v[52:55], v[24:27], v[108:111]
    ds_read_b64_tr_b16 v[78:79], v15 offset:17984
    v_mfma_f32_16x16x32_bf16 v[136:139], v[52:55], v[28:31], v[136:139]
    ds_read_b64_tr_b16 v[80:81], v15 offset:14432
    ds_read_b64_tr_b16 v[82:83], v15 offset:18016
    v_mfma_f32_16x16x32_bf16 v[112:115], v[56:59], v[24:27], v[112:115]
    ds_read_b64_tr_b16 v[84:85], v15 offset:14464
    v_mfma_f32_16x16x32_bf16 v[140:143], v[56:59], v[28:31], v[140:143]
    ds_read_b64_tr_b16 v[86:87], v15 offset:18048
    v_mfma_f32_16x16x32_bf16 v[116:119], v[60:63], v[24:27], v[116:119]
    ds_read_b64_tr_b16 v[88:89], v15 offset:14496
    v_mfma_f32_16x16x32_bf16 v[144:147], v[60:63], v[28:31], v[144:147]
    ds_read_b64_tr_b16 v[90:91], v15 offset:18080
    v_mfma_f32_16x16x32_bf16 v[120:123], v[64:67], v[24:27], v[120:123]
    ds_read_b64_tr_b16 v[92:93], v15 offset:14528
    v_mfma_f32_16x16x32_bf16 v[148:151], v[64:67], v[28:31], v[148:151]
    ds_read_b64_tr_b16 v[94:95], v15 offset:18112
    s_waitcnt lgkmcnt(0)
    s_barrier
    v_mfma_f32_16x16x32_bf16 v[96:99], v[68:71], v[32:35], v[96:99]
    ds_read_b128 v[24:27], v18 offset:0
    ds_read_b128 v[28:31], v18 offset:1024
    v_mfma_f32_16x16x32_bf16 v[124:127], v[68:71], v[36:39], v[124:127]
    ds_read_b64_tr_b16 v[40:41], v15 offset:21504
    v_mfma_f32_16x16x32_bf16 v[100:103], v[72:75], v[32:35], v[100:103]
    ds_read_b64_tr_b16 v[42:43], v15 offset:25088
    v_mfma_f32_16x16x32_bf16 v[128:131], v[72:75], v[36:39], v[128:131]
    ds_read_b64_tr_b16 v[44:45], v15 offset:21536
    v_mfma_f32_16x16x32_bf16 v[104:107], v[76:79], v[32:35], v[104:107]
    ds_read_b64_tr_b16 v[46:47], v15 offset:25120
    v_mfma_f32_16x16x32_bf16 v[132:135], v[76:79], v[36:39], v[132:135]
    ds_read_b64_tr_b16 v[48:49], v15 offset:21568
    v_mfma_f32_16x16x32_bf16 v[108:111], v[80:83], v[32:35], v[108:111]
    ds_read_b64_tr_b16 v[50:51], v15 offset:25152
    v_mfma_f32_16x16x32_bf16 v[136:139], v[80:83], v[36:39], v[136:139]
    ds_read_b64_tr_b16 v[52:53], v15 offset:21600
    ds_read_b64_tr_b16 v[54:55], v15 offset:25184
    v_mfma_f32_16x16x32_bf16 v[112:115], v[84:87], v[32:35], v[112:115]
    ds_read_b64_tr_b16 v[56:57], v15 offset:21632
    v_mfma_f32_16x16x32_bf16 v[140:143], v[84:87], v[36:39], v[140:143]
    ds_read_b64_tr_b16 v[58:59], v15 offset:25216
    v_mfma_f32_16x16x32_bf16 v[116:119], v[88:91], v[32:35], v[116:119]
    ds_read_b64_tr_b16 v[60:61], v15 offset:21664
    v_mfma_f32_16x16x32_bf16 v[144:147], v[88:91], v[36:39], v[144:147]
    ds_read_b64_tr_b16 v[62:63], v15 offset:25248
    v_mfma_f32_16x16x32_bf16 v[120:123], v[92:95], v[32:35], v[120:123]
    ds_read_b64_tr_b16 v[64:65], v15 offset:21696
    v_mfma_f32_16x16x32_bf16 v[148:151], v[92:95], v[36:39], v[148:151]
    ds_read_b64_tr_b16 v[66:67], v15 offset:25280
    s_waitcnt lgkmcnt(0)
    v_mfma_f32_16x16x32_bf16 v[96:99], v[40:43], v[24:27], v[96:99]
    ds_read_b128 v[32:35], v18 offset:8192
    ds_read_b128 v[36:39], v18 offset:9216
    v_mfma_f32_16x16x32_bf16 v[124:127], v[40:43], v[28:31], v[124:127]
    ds_read_b64_tr_b16 v[68:69], v15 offset:28672
    v_mfma_f32_16x16x32_bf16 v[100:103], v[44:47], v[24:27], v[100:103]
    ds_read_b64_tr_b16 v[70:71], v15 offset:32256
    v_mfma_f32_16x16x32_bf16 v[128:131], v[44:47], v[28:31], v[128:131]
    ds_read_b64_tr_b16 v[72:73], v15 offset:28704
    v_mfma_f32_16x16x32_bf16 v[104:107], v[48:51], v[24:27], v[104:107]
    ds_read_b64_tr_b16 v[74:75], v15 offset:32288
    v_mfma_f32_16x16x32_bf16 v[132:135], v[48:51], v[28:31], v[132:135]
    ds_read_b64_tr_b16 v[76:77], v15 offset:28736
    v_mfma_f32_16x16x32_bf16 v[108:111], v[52:55], v[24:27], v[108:111]
    ds_read_b64_tr_b16 v[78:79], v15 offset:32320
    v_mfma_f32_16x16x32_bf16 v[136:139], v[52:55], v[28:31], v[136:139]
    ds_read_b64_tr_b16 v[80:81], v15 offset:28768
    ds_read_b64_tr_b16 v[82:83], v15 offset:32352
    v_mfma_f32_16x16x32_bf16 v[112:115], v[56:59], v[24:27], v[112:115]
    ds_read_b64_tr_b16 v[84:85], v15 offset:28800
    v_mfma_f32_16x16x32_bf16 v[140:143], v[56:59], v[28:31], v[140:143]
    ds_read_b64_tr_b16 v[86:87], v15 offset:32384
    v_mfma_f32_16x16x32_bf16 v[116:119], v[60:63], v[24:27], v[116:119]
    ds_read_b64_tr_b16 v[88:89], v15 offset:28832
    v_mfma_f32_16x16x32_bf16 v[144:147], v[60:63], v[28:31], v[144:147]
    ds_read_b64_tr_b16 v[90:91], v15 offset:32416
    v_mfma_f32_16x16x32_bf16 v[120:123], v[64:67], v[24:27], v[120:123]
    ds_read_b64_tr_b16 v[92:93], v15 offset:28864
    v_mfma_f32_16x16x32_bf16 v[148:151], v[64:67], v[28:31], v[148:151]
    ds_read_b64_tr_b16 v[94:95], v15 offset:32448
    s_waitcnt lgkmcnt(0)
    s_barrier
    v_mov_b32 v4, 0
    v_mov_b32 v5, 32832
    ds_write_b32 v5, v4
    v_mfma_f32_16x16x32_bf16 v[96:99], v[68:71], v[32:35], v[96:99]
    ds_read_b128 v[24:27], v18 offset:16384
    ds_read_b128 v[28:31], v18 offset:17408
    v_mfma_f32_16x16x32_bf16 v[124:127], v[68:71], v[36:39], v[124:127]
    ds_read_b64_tr_b16 v[40:41], v15 offset:35840
    v_mfma_f32_16x16x32_bf16 v[100:103], v[72:75], v[32:35], v[100:103]
    ds_read_b64_tr_b16 v[42:43], v15 offset:39424
    v_mfma_f32_16x16x32_bf16 v[128:131], v[72:75], v[36:39], v[128:131]
    ds_read_b64_tr_b16 v[44:45], v15 offset:35872
    v_mfma_f32_16x16x32_bf16 v[104:107], v[76:79], v[32:35], v[104:107]
    ds_read_b64_tr_b16 v[46:47], v15 offset:39456
    v_mfma_f32_16x16x32_bf16 v[132:135], v[76:79], v[36:39], v[132:135]
    ds_read_b64_tr_b16 v[48:49], v15 offset:35904
    v_mfma_f32_16x16x32_bf16 v[108:111], v[80:83], v[32:35], v[108:111]
    ds_read_b64_tr_b16 v[50:51], v15 offset:39488
    v_mfma_f32_16x16x32_bf16 v[136:139], v[80:83], v[36:39], v[136:139]
    ds_read_b64_tr_b16 v[52:53], v15 offset:35936
    ds_read_b64_tr_b16 v[54:55], v15 offset:39520
    v_mfma_f32_16x16x32_bf16 v[112:115], v[84:87], v[32:35], v[112:115]
    ds_read_b64_tr_b16 v[56:57], v15 offset:35968
    v_mfma_f32_16x16x32_bf16 v[140:143], v[84:87], v[36:39], v[140:143]
    ds_read_b64_tr_b16 v[58:59], v15 offset:39552
    v_mfma_f32_16x16x32_bf16 v[116:119], v[88:91], v[32:35], v[116:119]
    ds_read_b64_tr_b16 v[60:61], v15 offset:36000
    v_mfma_f32_16x16x32_bf16 v[144:147], v[88:91], v[36:39], v[144:147]
    ds_read_b64_tr_b16 v[62:63], v15 offset:39584
    v_mfma_f32_16x16x32_bf16 v[120:123], v[92:95], v[32:35], v[120:123]
    ds_read_b64_tr_b16 v[64:65], v15 offset:36032
    v_mfma_f32_16x16x32_bf16 v[148:151], v[92:95], v[36:39], v[148:151]
    ds_read_b64_tr_b16 v[66:67], v15 offset:39616
    s_waitcnt lgkmcnt(0)
    v_mfma_f32_16x16x32_bf16 v[96:99], v[40:43], v[24:27], v[96:99]
    ds_read_b128 v[32:35], v18 offset:24576
    ds_read_b128 v[36:39], v18 offset:25600
    v_mfma_f32_16x16x32_bf16 v[124:127], v[40:43], v[28:31], v[124:127]
    ds_read_b64_tr_b16 v[68:69], v15 offset:43008
    v_mfma_f32_16x16x32_bf16 v[100:103], v[44:47], v[24:27], v[100:103]
    ds_read_b64_tr_b16 v[70:71], v15 offset:46592
    v_mfma_f32_16x16x32_bf16 v[128:131], v[44:47], v[28:31], v[128:131]
    ds_read_b64_tr_b16 v[72:73], v15 offset:43040
    v_mfma_f32_16x16x32_bf16 v[104:107], v[48:51], v[24:27], v[104:107]
    ds_read_b64_tr_b16 v[74:75], v15 offset:46624
    v_mfma_f32_16x16x32_bf16 v[132:135], v[48:51], v[28:31], v[132:135]
    ds_read_b64_tr_b16 v[76:77], v15 offset:43072
    v_mfma_f32_16x16x32_bf16 v[108:111], v[52:55], v[24:27], v[108:111]
    ds_read_b64_tr_b16 v[78:79], v15 offset:46656
    v_mfma_f32_16x16x32_bf16 v[136:139], v[52:55], v[28:31], v[136:139]
    ds_read_b64_tr_b16 v[80:81], v15 offset:43104
    ds_read_b64_tr_b16 v[82:83], v15 offset:46688
    v_mfma_f32_16x16x32_bf16 v[112:115], v[56:59], v[24:27], v[112:115]
    ds_read_b64_tr_b16 v[84:85], v15 offset:43136
    v_mfma_f32_16x16x32_bf16 v[140:143], v[56:59], v[28:31], v[140:143]
    ds_read_b64_tr_b16 v[86:87], v15 offset:46720
    v_mfma_f32_16x16x32_bf16 v[116:119], v[60:63], v[24:27], v[116:119]
    ds_read_b64_tr_b16 v[88:89], v15 offset:43168
    v_mfma_f32_16x16x32_bf16 v[144:147], v[60:63], v[28:31], v[144:147]
    ds_read_b64_tr_b16 v[90:91], v15 offset:46752
    v_mfma_f32_16x16x32_bf16 v[120:123], v[64:67], v[24:27], v[120:123]
    ds_read_b64_tr_b16 v[92:93], v15 offset:43200
    v_mfma_f32_16x16x32_bf16 v[148:151], v[64:67], v[28:31], v[148:151]
    ds_read_b64_tr_b16 v[94:95], v15 offset:46784
    s_waitcnt lgkmcnt(0)
    v_mfma_f32_16x16x32_bf16 v[96:99], v[68:71], v[32:35], v[96:99]
    v_mfma_f32_16x16x32_bf16 v[124:127], v[68:71], v[36:39], v[124:127]
    v_mfma_f32_16x16x32_bf16 v[100:103], v[72:75], v[32:35], v[100:103]
    v_mfma_f32_16x16x32_bf16 v[128:131], v[72:75], v[36:39], v[128:131]
    v_mfma_f32_16x16x32_bf16 v[104:107], v[76:79], v[32:35], v[104:107]
    v_mfma_f32_16x16x32_bf16 v[132:135], v[76:79], v[36:39], v[132:135]
    v_mfma_f32_16x16x32_bf16 v[108:111], v[80:83], v[32:35], v[108:111]
    v_mfma_f32_16x16x32_bf16 v[136:139], v[80:83], v[36:39], v[136:139]
    v_mfma_f32_16x16x32_bf16 v[112:115], v[84:87], v[32:35], v[112:115]
    v_mfma_f32_16x16x32_bf16 v[140:143], v[84:87], v[36:39], v[140:143]
    v_mfma_f32_16x16x32_bf16 v[116:119], v[88:91], v[32:35], v[116:119]
    v_mfma_f32_16x16x32_bf16 v[144:147], v[88:91], v[36:39], v[144:147]
    v_mfma_f32_16x16x32_bf16 v[120:123], v[92:95], v[32:35], v[120:123]
    v_mfma_f32_16x16x32_bf16 v[148:151], v[92:95], v[36:39], v[148:151]
    s_barrier
    s_waitcnt vmcnt(0)
    s_mov_b32 s50, 0x3b000000
    s_mov_b32 s51, 0x3727c5ac
    v_add_f32 v248, v240, v242
    v_add_f32 v249, v241, v243
    v_add_f32 v250, v244, v246
    v_add_f32 v251, v245, v247
    v_mov_b32 v252, v248
    v_mov_b32 v253, v249
    v_mov_b32 v254, v250
    v_mov_b32 v255, v251
    v_permlane32_swap_b32 v248, v252
    v_permlane32_swap_b32 v249, v253
    v_permlane32_swap_b32 v250, v254
    v_permlane32_swap_b32 v251, v255
    v_add_f32 v248, v248, v252
    v_add_f32 v249, v249, v253
    v_add_f32 v250, v250, v254
    v_add_f32 v251, v251, v255
    v_mov_b32 v252, v248
    v_mov_b32 v253, v249
    v_mov_b32 v254, v250
    v_mov_b32 v255, v251
    v_permlane16_swap_b32 v248, v252
    v_permlane16_swap_b32 v249, v253
    v_permlane16_swap_b32 v250, v254
    v_permlane16_swap_b32 v251, v255
    v_add_f32 v248, v248, v252
    v_add_f32 v249, v249, v253
    v_add_f32 v250, v250, v254
    v_add_f32 v251, v251, v255
    v_mul_f32 v248, s50, v248
    v_mul_f32 v249, s50, v249
    v_fma_f32 v249, -v248, v248, v249
    v_max_f32 v249, 0, v249
    v_add_f32 v249, s51, v249
    v_rsq_f32 v249, v249
    s_nop 0
    v_mul_f32 v248, -v248, v249
    v_mul_f32 v250, s50, v250
    v_mul_f32 v251, s50, v251
    v_fma_f32 v251, -v250, v250, v251
    v_max_f32 v251, 0, v251
    v_add_f32 v251, s51, v251
    v_rsq_f32 v251, v251
    s_nop 0
    v_mul_f32 v250, -v250, v251
    s_mov_b32 s50, 0xbfb8aa3b
    s_mul_i32 s46, s54, 57344
    s_mul_i32 s47, s41, 7
    s_lshr_b32 s47, s47, 1
    s_lshl_b32 s47, s47, 10
    s_add_u32 s46, s46, s47
    s_add_u32 s46, s46, 4194304
    s_add_u32 s47, s46, 57344
    v_pk_mul_f32 v[68:69], v[248:249], v[164:165] op_sel_hi:[0,1]
    v_pk_mul_f32 v[70:71], v[248:249], v[166:167] op_sel_hi:[0,1]
    v_pk_fma_f32 v[96:97], v[248:249], v[96:97], v[68:69] op_sel:[1,0,0] op_sel_hi:[1,1,1]
    v_pk_fma_f32 v[98:99], v[248:249], v[98:99], v[70:71] op_sel:[1,0,0] op_sel_hi:[1,1,1]
    v_pk_mul_f32 v[68:69], s[50:51], v[96:97] op_sel_hi:[0,1]
    v_pk_mul_f32 v[70:71], s[50:51], v[98:99] op_sel_hi:[0,1]
    v_exp_f32 v68, v68
    v_exp_f32 v69, v69
    v_exp_f32 v70, v70
    v_exp_f32 v71, v71
    v_pk_add_f32 v[68:69], v[68:69], 1.0 op_sel_hi:[1,0]
    v_pk_add_f32 v[70:71], v[70:71], 1.0 op_sel_hi:[1,0]
    v_rcp_f32 v68, v68
    v_rcp_f32 v69, v69
    v_rcp_f32 v70, v70
    v_rcp_f32 v71, v71
    v_pk_mul_f32 v[96:97], v[96:97], v[68:69]
    v_pk_mul_f32 v[98:99], v[98:99], v[70:71]
    v_cvt_pk_bf16_f32 v40, v96, v97
    v_cvt_pk_bf16_f32 v41, v98, v99
    v_pk_mul_f32 v[72:73], v[248:249], v[168:169] op_sel_hi:[0,1]
    v_pk_mul_f32 v[74:75], v[248:249], v[170:171] op_sel_hi:[0,1]
    v_pk_fma_f32 v[100:101], v[248:249], v[100:101], v[72:73] op_sel:[1,0,0] op_sel_hi:[1,1,1]
    v_pk_fma_f32 v[102:103], v[248:249], v[102:103], v[74:75] op_sel:[1,0,0] op_sel_hi:[1,1,1]
    v_pk_mul_f32 v[72:73], s[50:51], v[100:101] op_sel_hi:[0,1]
    v_pk_mul_f32 v[74:75], s[50:51], v[102:103] op_sel_hi:[0,1]
    v_exp_f32 v72, v72
    v_exp_f32 v73, v73
    v_exp_f32 v74, v74
    v_exp_f32 v75, v75
    v_pk_add_f32 v[72:73], v[72:73], 1.0 op_sel_hi:[1,0]
    v_pk_add_f32 v[74:75], v[74:75], 1.0 op_sel_hi:[1,0]
    v_rcp_f32 v72, v72
    v_rcp_f32 v73, v73
    v_rcp_f32 v74, v74
    v_rcp_f32 v75, v75
    v_pk_mul_f32 v[100:101], v[100:101], v[72:73]
    v_pk_mul_f32 v[102:103], v[102:103], v[74:75]
    v_cvt_pk_bf16_f32 v42, v100, v101
    v_cvt_pk_bf16_f32 v43, v102, v103
    v_pk_mul_f32 v[68:69], v[248:249], v[172:173] op_sel_hi:[0,1]
    v_pk_mul_f32 v[70:71], v[248:249], v[174:175] op_sel_hi:[0,1]
    v_pk_fma_f32 v[104:105], v[248:249], v[104:105], v[68:69] op_sel:[1,0,0] op_sel_hi:[1,1,1]
    v_pk_fma_f32 v[106:107], v[248:249], v[106:107], v[70:71] op_sel:[1,0,0] op_sel_hi:[1,1,1]
    v_pk_mul_f32 v[68:69], s[50:51], v[104:105] op_sel_hi:[0,1]
    v_pk_mul_f32 v[70:71], s[50:51], v[106:107] op_sel_hi:[0,1]
    v_exp_f32 v68, v68
    v_exp_f32 v69, v69
    v_exp_f32 v70, v70
    v_exp_f32 v71, v71
    v_pk_add_f32 v[68:69], v[68:69], 1.0 op_sel_hi:[1,0]
    v_pk_add_f32 v[70:71], v[70:71], 1.0 op_sel_hi:[1,0]
    v_rcp_f32 v68, v68
    v_rcp_f32 v69, v69
    v_rcp_f32 v70, v70
    v_rcp_f32 v71, v71
    v_pk_mul_f32 v[104:105], v[104:105], v[68:69]
    v_pk_mul_f32 v[106:107], v[106:107], v[70:71]
    v_cvt_pk_bf16_f32 v44, v104, v105
    v_cvt_pk_bf16_f32 v45, v106, v107
    v_pk_mul_f32 v[72:73], v[248:249], v[176:177] op_sel_hi:[0,1]
    v_pk_mul_f32 v[74:75], v[248:249], v[178:179] op_sel_hi:[0,1]
    v_pk_fma_f32 v[108:109], v[248:249], v[108:109], v[72:73] op_sel:[1,0,0] op_sel_hi:[1,1,1]
    v_pk_fma_f32 v[110:111], v[248:249], v[110:111], v[74:75] op_sel:[1,0,0] op_sel_hi:[1,1,1]
    v_pk_mul_f32 v[72:73], s[50:51], v[108:109] op_sel_hi:[0,1]
    v_pk_mul_f32 v[74:75], s[50:51], v[110:111] op_sel_hi:[0,1]
    v_exp_f32 v72, v72
    v_exp_f32 v73, v73
    v_exp_f32 v74, v74
    v_exp_f32 v75, v75
    v_pk_add_f32 v[72:73], v[72:73], 1.0 op_sel_hi:[1,0]
    v_pk_add_f32 v[74:75], v[74:75], 1.0 op_sel_hi:[1,0]
    v_rcp_f32 v72, v72
    v_rcp_f32 v73, v73
    v_rcp_f32 v74, v74
    v_rcp_f32 v75, v75
    v_pk_mul_f32 v[108:109], v[108:109], v[72:73]
    v_pk_mul_f32 v[110:111], v[110:111], v[74:75]
    v_cvt_pk_bf16_f32 v46, v108, v109
    v_cvt_pk_bf16_f32 v47, v110, v111
    v_pk_mul_f32 v[68:69], v[248:249], v[180:181] op_sel_hi:[0,1]
    v_pk_mul_f32 v[70:71], v[248:249], v[182:183] op_sel_hi:[0,1]
    v_pk_fma_f32 v[112:113], v[248:249], v[112:113], v[68:69] op_sel:[1,0,0] op_sel_hi:[1,1,1]
    v_pk_fma_f32 v[114:115], v[248:249], v[114:115], v[70:71] op_sel:[1,0,0] op_sel_hi:[1,1,1]
    v_pk_mul_f32 v[68:69], s[50:51], v[112:113] op_sel_hi:[0,1]
    v_pk_mul_f32 v[70:71], s[50:51], v[114:115] op_sel_hi:[0,1]
    v_exp_f32 v68, v68
    v_exp_f32 v69, v69
    v_exp_f32 v70, v70
    v_exp_f32 v71, v71
    v_pk_add_f32 v[68:69], v[68:69], 1.0 op_sel_hi:[1,0]
    v_pk_add_f32 v[70:71], v[70:71], 1.0 op_sel_hi:[1,0]
    v_rcp_f32 v68, v68
    v_rcp_f32 v69, v69
    v_rcp_f32 v70, v70
    v_rcp_f32 v71, v71
    v_pk_mul_f32 v[112:113], v[112:113], v[68:69]
    v_pk_mul_f32 v[114:115], v[114:115], v[70:71]
    v_cvt_pk_bf16_f32 v48, v112, v113
    v_cvt_pk_bf16_f32 v49, v114, v115
    v_pk_mul_f32 v[72:73], v[248:249], v[184:185] op_sel_hi:[0,1]
    v_pk_mul_f32 v[74:75], v[248:249], v[186:187] op_sel_hi:[0,1]
    v_pk_fma_f32 v[116:117], v[248:249], v[116:117], v[72:73] op_sel:[1,0,0] op_sel_hi:[1,1,1]
    v_pk_fma_f32 v[118:119], v[248:249], v[118:119], v[74:75] op_sel:[1,0,0] op_sel_hi:[1,1,1]
    v_pk_mul_f32 v[72:73], s[50:51], v[116:117] op_sel_hi:[0,1]
    v_pk_mul_f32 v[74:75], s[50:51], v[118:119] op_sel_hi:[0,1]
    v_exp_f32 v72, v72
    v_exp_f32 v73, v73
    v_exp_f32 v74, v74
    v_exp_f32 v75, v75
    v_pk_add_f32 v[72:73], v[72:73], 1.0 op_sel_hi:[1,0]
    v_pk_add_f32 v[74:75], v[74:75], 1.0 op_sel_hi:[1,0]
    v_rcp_f32 v72, v72
    v_rcp_f32 v73, v73
    v_rcp_f32 v74, v74
    v_rcp_f32 v75, v75
    v_pk_mul_f32 v[116:117], v[116:117], v[72:73]
    v_pk_mul_f32 v[118:119], v[118:119], v[74:75]
    v_cvt_pk_bf16_f32 v50, v116, v117
    v_cvt_pk_bf16_f32 v51, v118, v119
    v_pk_mul_f32 v[68:69], v[248:249], v[188:189] op_sel_hi:[0,1]
    v_pk_mul_f32 v[70:71], v[248:249], v[190:191] op_sel_hi:[0,1]
    v_pk_fma_f32 v[120:121], v[248:249], v[120:121], v[68:69] op_sel:[1,0,0] op_sel_hi:[1,1,1]
    v_pk_fma_f32 v[122:123], v[248:249], v[122:123], v[70:71] op_sel:[1,0,0] op_sel_hi:[1,1,1]
    v_pk_mul_f32 v[68:69], s[50:51], v[120:121] op_sel_hi:[0,1]
    v_pk_mul_f32 v[70:71], s[50:51], v[122:123] op_sel_hi:[0,1]
    v_exp_f32 v68, v68
    v_exp_f32 v69, v69
    v_exp_f32 v70, v70
    v_exp_f32 v71, v71
    v_pk_add_f32 v[68:69], v[68:69], 1.0 op_sel_hi:[1,0]
    v_pk_add_f32 v[70:71], v[70:71], 1.0 op_sel_hi:[1,0]
    v_rcp_f32 v68, v68
    v_rcp_f32 v69, v69
    v_rcp_f32 v70, v70
    v_rcp_f32 v71, v71
    v_pk_mul_f32 v[120:121], v[120:121], v[68:69]
    v_pk_mul_f32 v[122:123], v[122:123], v[70:71]
    v_cvt_pk_bf16_f32 v52, v120, v121
    v_cvt_pk_bf16_f32 v53, v122, v123
    s_cmp_eq_u32 s101, 0
    s_cbranch_scc1 L_dsl2
    s_bitcmp1_b32 s41, 0
    s_cbranch_scc1 L_p3oddf0
    buffer_store_dwordx4 v[40:43], v7, s[32:35], s46 offen offset:0
    buffer_store_dwordx4 v[44:47], v7, s[32:35], s46 offen offset:1024
    buffer_store_dwordx4 v[48:51], v7, s[32:35], s46 offen offset:2048
    buffer_store_dwordx2 v[52:53], v7, s[32:35], s46 offen offset:3072
    s_branch L_p3stf0
L_p3oddf0:
    buffer_store_dwordx2 v[40:41], v7, s[32:35], s46 offen offset:8
    buffer_store_dwordx4 v[42:45], v7, s[32:35], s46 offen offset:1024
    buffer_store_dwordx4 v[46:49], v7, s[32:35], s46 offen offset:2048
    buffer_store_dwordx4 v[50:53], v7, s[32:35], s46 offen offset:3072
L_p3stf0:
    s_branch L_djn2
L_dsl2:
    s_bitcmp1_b32 s41, 0
    s_cbranch_scc1 L_p3oddsc10
    buffer_store_dwordx4 v[40:43], v7, s[32:35], s46 offen offset:0 sc1
    buffer_store_dwordx4 v[44:47], v7, s[32:35], s46 offen offset:1024 sc1
    buffer_store_dwordx4 v[48:51], v7, s[32:35], s46 offen offset:2048 sc1
    buffer_store_dwordx2 v[52:53], v7, s[32:35], s46 offen offset:3072 sc1
    s_branch L_p3stsc10
L_p3oddsc10:
    buffer_store_dwordx2 v[40:41], v7, s[32:35], s46 offen offset:8 sc1
    buffer_store_dwordx4 v[42:45], v7, s[32:35], s46 offen offset:1024 sc1
    buffer_store_dwordx4 v[46:49], v7, s[32:35], s46 offen offset:2048 sc1
    buffer_store_dwordx4 v[50:53], v7, s[32:35], s46 offen offset:3072 sc1
L_p3stsc10:
L_djn2:
    v_pk_mul_f32 v[72:73], v[250:251], v[164:165] op_sel_hi:[0,1]
    v_pk_mul_f32 v[74:75], v[250:251], v[166:167] op_sel_hi:[0,1]
    v_pk_fma_f32 v[124:125], v[250:251], v[124:125], v[72:73] op_sel:[1,0,0] op_sel_hi:[1,1,1]
    v_pk_fma_f32 v[126:127], v[250:251], v[126:127], v[74:75] op_sel:[1,0,0] op_sel_hi:[1,1,1]
    v_pk_mul_f32 v[72:73], s[50:51], v[124:125] op_sel_hi:[0,1]
    v_pk_mul_f32 v[74:75], s[50:51], v[126:127] op_sel_hi:[0,1]
    v_exp_f32 v72, v72
    v_exp_f32 v73, v73
    v_exp_f32 v74, v74
    v_exp_f32 v75, v75
    v_pk_add_f32 v[72:73], v[72:73], 1.0 op_sel_hi:[1,0]
    v_pk_add_f32 v[74:75], v[74:75], 1.0 op_sel_hi:[1,0]
    v_rcp_f32 v72, v72
    v_rcp_f32 v73, v73
    v_rcp_f32 v74, v74
    v_rcp_f32 v75, v75
    v_pk_mul_f32 v[124:125], v[124:125], v[72:73]
    v_pk_mul_f32 v[126:127], v[126:127], v[74:75]
    v_cvt_pk_bf16_f32 v54, v124, v125
    v_cvt_pk_bf16_f32 v55, v126, v127
    v_pk_mul_f32 v[68:69], v[250:251], v[168:169] op_sel_hi:[0,1]
    v_pk_mul_f32 v[70:71], v[250:251], v[170:171] op_sel_hi:[0,1]
    v_pk_fma_f32 v[128:129], v[250:251], v[128:129], v[68:69] op_sel:[1,0,0] op_sel_hi:[1,1,1]
    v_pk_fma_f32 v[130:131], v[250:251], v[130:131], v[70:71] op_sel:[1,0,0] op_sel_hi:[1,1,1]
    v_pk_mul_f32 v[68:69], s[50:51], v[128:129] op_sel_hi:[0,1]
    v_pk_mul_f32 v[70:71], s[50:51], v[130:131] op_sel_hi:[0,1]
    v_exp_f32 v68, v68
    v_exp_f32 v69, v69
    v_exp_f32 v70, v70
    v_exp_f32 v71, v71
    v_pk_add_f32 v[68:69], v[68:69], 1.0 op_sel_hi:[1,0]
    v_pk_add_f32 v[70:71], v[70:71], 1.0 op_sel_hi:[1,0]
    v_rcp_f32 v68, v68
    v_rcp_f32 v69, v69
    v_rcp_f32 v70, v70
    v_rcp_f32 v71, v71
    v_pk_mul_f32 v[128:129], v[128:129], v[68:69]
    v_pk_mul_f32 v[130:131], v[130:131], v[70:71]
    v_cvt_pk_bf16_f32 v56, v128, v129
    v_cvt_pk_bf16_f32 v57, v130, v131
    v_pk_mul_f32 v[72:73], v[250:251], v[172:173] op_sel_hi:[0,1]
    v_pk_mul_f32 v[74:75], v[250:251], v[174:175] op_sel_hi:[0,1]
    v_pk_fma_f32 v[132:133], v[250:251], v[132:133], v[72:73] op_sel:[1,0,0] op_sel_hi:[1,1,1]
    v_pk_fma_f32 v[134:135], v[250:251], v[134:135], v[74:75] op_sel:[1,0,0] op_sel_hi:[1,1,1]
    v_pk_mul_f32 v[72:73], s[50:51], v[132:133] op_sel_hi:[0,1]
    v_pk_mul_f32 v[74:75], s[50:51], v[134:135] op_sel_hi:[0,1]
    v_exp_f32 v72, v72
    v_exp_f32 v73, v73
    v_exp_f32 v74, v74
    v_exp_f32 v75, v75
    v_pk_add_f32 v[72:73], v[72:73], 1.0 op_sel_hi:[1,0]
    v_pk_add_f32 v[74:75], v[74:75], 1.0 op_sel_hi:[1,0]
    v_rcp_f32 v72, v72
    v_rcp_f32 v73, v73
    v_rcp_f32 v74, v74
    v_rcp_f32 v75, v75
    v_pk_mul_f32 v[132:133], v[132:133], v[72:73]
    v_pk_mul_f32 v[134:135], v[134:135], v[74:75]
    v_cvt_pk_bf16_f32 v58, v132, v133
    v_cvt_pk_bf16_f32 v59, v134, v135
    v_pk_mul_f32 v[68:69], v[250:251], v[176:177] op_sel_hi:[0,1]
    v_pk_mul_f32 v[70:71], v[250:251], v[178:179] op_sel_hi:[0,1]
    v_pk_fma_f32 v[136:137], v[250:251], v[136:137], v[68:69] op_sel:[1,0,0] op_sel_hi:[1,1,1]
    v_pk_fma_f32 v[138:139], v[250:251], v[138:139], v[70:71] op_sel:[1,0,0] op_sel_hi:[1,1,1]
    v_pk_mul_f32 v[68:69], s[50:51], v[136:137] op_sel_hi:[0,1]
    v_pk_mul_f32 v[70:71], s[50:51], v[138:139] op_sel_hi:[0,1]
    v_exp_f32 v68, v68
    v_exp_f32 v69, v69
    v_exp_f32 v70, v70
    v_exp_f32 v71, v71
    v_pk_add_f32 v[68:69], v[68:69], 1.0 op_sel_hi:[1,0]
    v_pk_add_f32 v[70:71], v[70:71], 1.0 op_sel_hi:[1,0]
    v_rcp_f32 v68, v68
    v_rcp_f32 v69, v69
    v_rcp_f32 v70, v70
    v_rcp_f32 v71, v71
    v_pk_mul_f32 v[136:137], v[136:137], v[68:69]
    v_pk_mul_f32 v[138:139], v[138:139], v[70:71]
    v_cvt_pk_bf16_f32 v60, v136, v137
    v_cvt_pk_bf16_f32 v61, v138, v139
    v_pk_mul_f32 v[72:73], v[250:251], v[180:181] op_sel_hi:[0,1]
    v_pk_mul_f32 v[74:75], v[250:251], v[182:183] op_sel_hi:[0,1]
    v_pk_fma_f32 v[140:141], v[250:251], v[140:141], v[72:73] op_sel:[1,0,0] op_sel_hi:[1,1,1]
    v_pk_fma_f32 v[142:143], v[250:251], v[142:143], v[74:75] op_sel:[1,0,0] op_sel_hi:[1,1,1]
    v_pk_mul_f32 v[72:73], s[50:51], v[140:141] op_sel_hi:[0,1]
    v_pk_mul_f32 v[74:75], s[50:51], v[142:143] op_sel_hi:[0,1]
    v_exp_f32 v72, v72
    v_exp_f32 v73, v73
    v_exp_f32 v74, v74
    v_exp_f32 v75, v75
    v_pk_add_f32 v[72:73], v[72:73], 1.0 op_sel_hi:[1,0]
    v_pk_add_f32 v[74:75], v[74:75], 1.0 op_sel_hi:[1,0]
    v_rcp_f32 v72, v72
    v_rcp_f32 v73, v73
    v_rcp_f32 v74, v74
    v_rcp_f32 v75, v75
    v_pk_mul_f32 v[140:141], v[140:141], v[72:73]
    v_pk_mul_f32 v[142:143], v[142:143], v[74:75]
    v_cvt_pk_bf16_f32 v62, v140, v141
    v_cvt_pk_bf16_f32 v63, v142, v143
    v_pk_mul_f32 v[68:69], v[250:251], v[184:185] op_sel_hi:[0,1]
    v_pk_mul_f32 v[70:71], v[250:251], v[186:187] op_sel_hi:[0,1]
    v_pk_fma_f32 v[144:145], v[250:251], v[144:145], v[68:69] op_sel:[1,0,0] op_sel_hi:[1,1,1]
    v_pk_fma_f32 v[146:147], v[250:251], v[146:147], v[70:71] op_sel:[1,0,0] op_sel_hi:[1,1,1]
    v_pk_mul_f32 v[68:69], s[50:51], v[144:145] op_sel_hi:[0,1]
    v_pk_mul_f32 v[70:71], s[50:51], v[146:147] op_sel_hi:[0,1]
    v_exp_f32 v68, v68
    v_exp_f32 v69, v69
    v_exp_f32 v70, v70
    v_exp_f32 v71, v71
    v_pk_add_f32 v[68:69], v[68:69], 1.0 op_sel_hi:[1,0]
    v_pk_add_f32 v[70:71], v[70:71], 1.0 op_sel_hi:[1,0]
    v_rcp_f32 v68, v68
    v_rcp_f32 v69, v69
    v_rcp_f32 v70, v70
    v_rcp_f32 v71, v71
    v_pk_mul_f32 v[144:145], v[144:145], v[68:69]
    v_pk_mul_f32 v[146:147], v[146:147], v[70:71]
    v_cvt_pk_bf16_f32 v64, v144, v145
    v_cvt_pk_bf16_f32 v65, v146, v147
    v_pk_mul_f32 v[72:73], v[250:251], v[188:189] op_sel_hi:[0,1]
    v_pk_mul_f32 v[74:75], v[250:251], v[190:191] op_sel_hi:[0,1]
    v_pk_fma_f32 v[148:149], v[250:251], v[148:149], v[72:73] op_sel:[1,0,0] op_sel_hi:[1,1,1]
    v_pk_fma_f32 v[150:151], v[250:251], v[150:151], v[74:75] op_sel:[1,0,0] op_sel_hi:[1,1,1]
    v_pk_mul_f32 v[72:73], s[50:51], v[148:149] op_sel_hi:[0,1]
    v_pk_mul_f32 v[74:75], s[50:51], v[150:151] op_sel_hi:[0,1]
    v_exp_f32 v72, v72
    v_exp_f32 v73, v73
    v_exp_f32 v74, v74
    v_exp_f32 v75, v75
    v_pk_add_f32 v[72:73], v[72:73], 1.0 op_sel_hi:[1,0]
    v_pk_add_f32 v[74:75], v[74:75], 1.0 op_sel_hi:[1,0]
    v_rcp_f32 v72, v72
    v_rcp_f32 v73, v73
    v_rcp_f32 v74, v74
    v_rcp_f32 v75, v75
    v_pk_mul_f32 v[148:149], v[148:149], v[72:73]
    v_pk_mul_f32 v[150:151], v[150:151], v[74:75]
    v_cvt_pk_bf16_f32 v66, v148, v149
    v_cvt_pk_bf16_f32 v67, v150, v151
    s_cmp_eq_u32 s101, 0
    s_cbranch_scc1 L_dsl3
    s_bitcmp1_b32 s41, 0
    s_cbranch_scc1 L_p3oddf1
    buffer_store_dwordx4 v[54:57], v7, s[32:35], s47 offen offset:0
    buffer_store_dwordx4 v[58:61], v7, s[32:35], s47 offen offset:1024
    buffer_store_dwordx4 v[62:65], v7, s[32:35], s47 offen offset:2048
    buffer_store_dwordx2 v[66:67], v7, s[32:35], s47 offen offset:3072
    s_branch L_p3stf1
L_p3oddf1:
    buffer_store_dwordx2 v[54:55], v7, s[32:35], s47 offen offset:8
    buffer_store_dwordx4 v[56:59], v7, s[32:35], s47 offen offset:1024
    buffer_store_dwordx4 v[60:63], v7, s[32:35], s47 offen offset:2048
    buffer_store_dwordx4 v[64:67], v7, s[32:35], s47 offen offset:3072
L_p3stf1:
    s_branch L_djn3
L_dsl3:
    s_bitcmp1_b32 s41, 0
    s_cbranch_scc1 L_p3oddsc11
    buffer_store_dwordx4 v[54:57], v7, s[32:35], s47 offen offset:0 sc1
    buffer_store_dwordx4 v[58:61], v7, s[32:35], s47 offen offset:1024 sc1
    buffer_store_dwordx4 v[62:65], v7, s[32:35], s47 offen offset:2048 sc1
    buffer_store_dwordx2 v[66:67], v7, s[32:35], s47 offen offset:3072 sc1
    s_branch L_p3stsc11
L_p3oddsc11:
    buffer_store_dwordx2 v[54:55], v7, s[32:35], s47 offen offset:8 sc1
    buffer_store_dwordx4 v[56:59], v7, s[32:35], s47 offen offset:1024 sc1
    buffer_store_dwordx4 v[60:63], v7, s[32:35], s47 offen offset:2048 sc1
    buffer_store_dwordx4 v[64:67], v7, s[32:35], s47 offen offset:3072 sc1
L_p3stsc11:
L_djn3:
    s_waitcnt vmcnt(0)
    s_mov_b64 exec, 1
    v_mov_b32 v5, 32832
    v_mov_b32 v4, 1
    ds_add_rtn_u32 v6, v5, v4
    s_waitcnt lgkmcnt(0)
    v_readfirstlane_b32 s64, v6
    s_nop 1
    s_cmp_lg_u32 s64, 3
    s_cbranch_scc1 L_sg1
    v_mov_b32 v4, s99
    s_mov_b32 s64, 8192
    s_cmp_eq_u32 s101, 0
    s_cbranch_scc1 L_dsl4
    buffer_store_dword v4, v8, s[32:35], s64 offen
    s_branch L_djn4
L_dsl4:
    buffer_store_dword v4, v8, s[32:35], s64 offen sc1
L_djn4:
L_sg1:
    s_mov_b64 exec, -1
    s_lshl_b32 s50, s3, 3
    s_lshl_b32 s51, s57, 2
    s_add_u32 s50, s50, s51
    s_add_u32 s51, s44, 0
    s_and_b32 s51, s51, 3
    s_add_u32 s51, s51, s50
    s_mul_i32 s46, s51, 57344
    s_mul_i32 s51, s44, 14336
    s_add_u32 s46, s46, s51
    s_add_u32 s46, s46, 4194304
    s_add_u32 s51, s44, 1
    s_and_b32 s51, s51, 3
    s_add_u32 s51, s51, s50
    s_mul_i32 s47, s51, 57344
    s_mul_i32 s51, s44, 14336
    s_add_u32 s47, s47, s51
    s_add_u32 s47, s47, 4194304
    s_add_u32 s51, s44, 2
    s_and_b32 s51, s51, 3
    s_add_u32 s51, s51, s50
    s_mul_i32 s48, s51, 57344
    s_mul_i32 s51, s44, 14336
    s_add_u32 s48, s48, s51
    s_add_u32 s48, s48, 4194304
    s_add_u32 s51, s44, 3
    s_and_b32 s51, s51, 3
    s_add_u32 s51, s51, s50
    s_mul_i32 s49, s51, 57344
    s_mul_i32 s51, s44, 14336
    s_add_u32 s49, s49, s51
    s_add_u32 s49, s49, 4194304
    s_lshl_b32 s69, s44, 12
    s_setprio 3
    s_cmp_lg_u32 s42, 0
    s_cbranch_scc1 L_pollA3_ok
    s_mov_b32 s58, 0
    s_lshl_b32 s64, s3, 8
    s_add_u32 s64, s64, 13639680
    v_and_b32 v5, 15, v1
    v_lshlrev_b32 v5, 2, v5
L_pollA3:
    buffer_load_dword v4, v5, s[32:35], s64 offen sc1
    s_waitcnt vmcnt(0)
    v_cmp_ne_u32 vcc, s99, v4
    s_add_u32 s58, s58, 1
    s_cbranch_vccz L_pollA3_ok
    s_sleep 1
    s_cmp_lt_u32 s58, 0x8000
    s_cbranch_scc1 L_pollA3
L_pollA3_ok:
    s_barrier
    s_add_u32 s7, s6, 0
    s_sub_u32 s65, s7, 14
    s_cmp_ge_u32 s7, 14
    s_cselect_b32 s7, s65, s7
    s_lshl_b32 s7, s7, 10
    s_add_u32 m0, s69, 0
    s_add_u32 s64, s46, s7
    buffer_load_dwordx4 v7, s[32:35], s64 offen sc1 lds
    s_add_u32 m0, s69, 1024
    s_add_u32 s64, s47, s7
    buffer_load_dwordx4 v7, s[32:35], s64 offen sc1 lds
    s_add_u32 m0, s69, 2048
    s_add_u32 s64, s48, s7
    buffer_load_dwordx4 v7, s[32:35], s64 offen sc1 lds
    s_add_u32 m0, s69, 3072
    s_add_u32 s64, s49, s7
    buffer_load_dwordx4 v7, s[32:35], s64 offen sc1 lds
    s_add_u32 s7, s6, 1
    s_sub_u32 s65, s7, 14
    s_cmp_ge_u32 s7, 14
    s_cselect_b32 s7, s65, s7
    s_lshl_b32 s7, s7, 10
    s_add_u32 m0, s69, 16384
    s_add_u32 s64, s46, s7
    buffer_load_dwordx4 v7, s[32:35], s64 offen sc1 lds
    s_add_u32 m0, s69, 17408
    s_add_u32 s64, s47, s7
    buffer_load_dwordx4 v7, s[32:35], s64 offen sc1 lds
    s_add_u32 m0, s69, 18432
    s_add_u32 s64, s48, s7
    buffer_load_dwordx4 v7, s[32:35], s64 offen sc1 lds
    s_add_u32 m0, s69, 19456
    s_add_u32 s64, s49, s7
    buffer_load_dwordx4 v7, s[32:35], s64 offen sc1 lds
    s_add_u32 s7, s6, 2
    s_sub_u32 s65, s7, 14
    s_cmp_ge_u32 s7, 14
    s_cselect_b32 s7, s65, s7
    s_lshl_b32 s7, s7, 10
    s_add_u32 m0, s69, 32768
    s_add_u32 s64, s46, s7
    buffer_load_dwordx4 v7, s[32:35], s64 offen sc1 lds
    s_add_u32 m0, s69, 33792
    s_add_u32 s64, s47, s7
    buffer_load_dwordx4 v7, s[32:35], s64 offen sc1 lds
    s_add_u32 m0, s69, 34816
    s_add_u32 s64, s48, s7
    buffer_load_dwordx4 v7, s[32:35], s64 offen sc1 lds
    s_add_u32 m0, s69, 35840
    s_add_u32 s64, s49, s7
    buffer_load_dwordx4 v7, s[32:35], s64 offen sc1 lds
    s_waitcnt vmcnt(8)
    s_barrier
    s_waitcnt vmcnt(4)
    s_barrier
    s_add_u32 s7, s6, 3
    s_sub_u32 s65, s7, 14
    s_cmp_ge_u32 s7, 14
    s_cselect_b32 s7, s65, s7
    s_lshl_b32 s7, s7, 10
    s_add_u32 m0, s69, 0
    s_add_u32 s64, s46, s7
    buffer_load_dwordx4 v7, s[32:35], s64 offen sc1 lds
    s_add_u32 m0, s69, 1024
    s_add_u32 s64, s47, s7
    buffer_load_dwordx4 v7, s[32:35], s64 offen sc1 lds
    s_add_u32 m0, s69, 2048
    s_add_u32 s64, s48, s7
    buffer_load_dwordx4 v7, s[32:35], s64 offen sc1 lds
    s_add_u32 m0, s69, 3072
    s_add_u32 s64, s49, s7
    buffer_load_dwordx4 v7, s[32:35], s64 offen sc1 lds
    s_waitcnt vmcnt(4)
    s_barrier
    s_add_u32 s7, s6, 4
    s_sub_u32 s65, s7, 14
    s_cmp_ge_u32 s7, 14
    s_cselect_b32 s7, s65, s7
    s_lshl_b32 s7, s7, 10
    s_add_u32 m0, s69, 16384
    s_add_u32 s64, s46, s7
    buffer_load_dwordx4 v7, s[32:35], s64 offen sc1 lds
    s_add_u32 m0, s69, 17408
    s_add_u32 s64, s47, s7
    buffer_load_dwordx4 v7, s[32:35], s64 offen sc1 lds
    s_add_u32 m0, s69, 18432
    s_add_u32 s64, s48, s7
    buffer_load_dwordx4 v7, s[32:35], s64 offen sc1 lds
    s_add_u32 m0, s69, 19456
    s_add_u32 s64, s49, s7
    buffer_load_dwordx4 v7, s[32:35], s64 offen sc1 lds
    s_waitcnt vmcnt(4)
    s_barrier
    s_add_u32 s7, s6, 5
    s_sub_u32 s65, s7, 14
    s_cmp_ge_u32 s7, 14
    s_cselect_b32 s7, s65, s7
    s_lshl_b32 s7, s7, 10
    s_add_u32 m0, s69, 32768
    s_add_u32 s64, s46, s7
    buffer_load_dwordx4 v7, s[32:35], s64 offen sc1 lds
    s_add_u32 m0, s69, 33792
    s_add_u32 s64, s47, s7
    buffer_load_dwordx4 v7, s[32:35], s64 offen sc1 lds
    s_add_u32 m0, s69, 34816
    s_add_u32 s64, s48, s7
    buffer_load_dwordx4 v7, s[32:35], s64 offen sc1 lds
    s_add_u32 m0, s69, 35840
    s_add_u32 s64, s49, s7
    buffer_load_dwordx4 v7, s[32:35], s64 offen sc1 lds
    s_waitcnt vmcnt(4)
    s_barrier
    s_add_u32 s7, s6, 6
    s_sub_u32 s65, s7, 14
    s_cmp_ge_u32 s7, 14
    s_cselect_b32 s7, s65, s7
    s_lshl_b32 s7, s7, 10
    s_add_u32 m0, s69, 0
    s_add_u32 s64, s46, s7
    buffer_load_dwordx4 v7, s[32:35], s64 offen sc1 lds
    s_add_u32 m0, s69, 1024
    s_add_u32 s64, s47, s7
    buffer_load_dwordx4 v7, s[32:35], s64 offen sc1 lds
    s_add_u32 m0, s69, 2048
    s_add_u32 s64, s48, s7
    buffer_load_dwordx4 v7, s[32:35], s64 offen sc1 lds
    s_add_u32 m0, s69, 3072
    s_add_u32 s64, s49, s7
    buffer_load_dwordx4 v7, s[32:35], s64 offen sc1 lds
    s_waitcnt vmcnt(4)
    s_barrier
    s_add_u32 s7, s6, 7
    s_sub_u32 s65, s7, 14
    s_cmp_ge_u32 s7, 14
    s_cselect_b32 s7, s65, s7
    s_lshl_b32 s7, s7, 10
    s_add_u32 m0, s69, 16384
    s_add_u32 s64, s46, s7
    buffer_load_dwordx4 v7, s[32:35], s64 offen sc1 lds
    s_add_u32 m0, s69, 17408
    s_add_u32 s64, s47, s7
    buffer_load_dwordx4 v7, s[32:35], s64 offen sc1 lds
    s_add_u32 m0, s69, 18432
    s_add_u32 s64, s48, s7
    buffer_load_dwordx4 v7, s[32:35], s64 offen sc1 lds
    s_add_u32 m0, s69, 19456
    s_add_u32 s64, s49, s7
    buffer_load_dwordx4 v7, s[32:35], s64 offen sc1 lds
    s_waitcnt vmcnt(4)
    s_barrier
    s_add_u32 s7, s6, 8
    s_sub_u32 s65, s7, 14
    s_cmp_ge_u32 s7, 14
    s_cselect_b32 s7, s65, s7
    s_lshl_b32 s7, s7, 10
    s_add_u32 m0, s69, 32768
    s_add_u32 s64, s46, s7
    buffer_load_dwordx4 v7, s[32:35], s64 offen sc1 lds
    s_add_u32 m0, s69, 33792
    s_add_u32 s64, s47, s7
    buffer_load_dwordx4 v7, s[32:35], s64 offen sc1 lds
    s_add_u32 m0, s69, 34816
    s_add_u32 s64, s48, s7
    buffer_load_dwordx4 v7, s[32:35], s64 offen sc1 lds
    s_add_u32 m0, s69, 35840
    s_add_u32 s64, s49, s7
    buffer_load_dwordx4 v7, s[32:35], s64 offen sc1 lds
    s_waitcnt vmcnt(4)
    s_barrier
    s_add_u32 s7, s6, 9
    s_sub_u32 s65, s7, 14
    s_cmp_ge_u32 s7, 14
    s_cselect_b32 s7, s65, s7
    s_lshl_b32 s7, s7, 10
    s_add_u32 m0, s69, 0
    s_add_u32 s64, s46, s7
    buffer_load_dwordx4 v7, s[32:35], s64 offen sc1 lds
    s_add_u32 m0, s69, 1024
    s_add_u32 s64, s47, s7
    buffer_load_dwordx4 v7, s[32:35], s64 offen sc1 lds
    s_add_u32 m0, s69, 2048
    s_add_u32 s64, s48, s7
    buffer_load_dwordx4 v7, s[32:35], s64 offen sc1 lds
    s_add_u32 m0, s69, 3072
    s_add_u32 s64, s49, s7
    buffer_load_dwordx4 v7, s[32:35], s64 offen sc1 lds
    s_waitcnt vmcnt(4)
    s_barrier
    s_add_u32 s7, s6, 10
    s_sub_u32 s65, s7, 14
    s_cmp_ge_u32 s7, 14
    s_cselect_b32 s7, s65, s7
    s_lshl_b32 s7, s7, 10
    s_add_u32 m0, s69, 16384
    s_add_u32 s64, s46, s7
    buffer_load_dwordx4 v7, s[32:35], s64 offen sc1 lds
    s_add_u32 m0, s69, 17408
    s_add_u32 s64, s47, s7
    buffer_load_dwordx4 v7, s[32:35], s64 offen sc1 lds
    s_add_u32 m0, s69, 18432
    s_add_u32 s64, s48, s7
    buffer_load_dwordx4 v7, s[32:35], s64 offen sc1 lds
    s_add_u32 m0, s69, 19456
    s_add_u32 s64, s49, s7
    buffer_load_dwordx4 v7, s[32:35], s64 offen sc1 lds
    s_waitcnt vmcnt(4)
    s_barrier
    s_add_u32 s7, s6, 11
    s_sub_u32 s65, s7, 14
    s_cmp_ge_u32 s7, 14
    s_cselect_b32 s7, s65, s7
    s_lshl_b32 s7, s7, 10
    s_add_u32 m0, s69, 32768
    s_add_u32 s64, s46, s7
    buffer_load_dwordx4 v7, s[32:35], s64 offen sc1 lds
    s_add_u32 m0, s69, 33792
    s_add_u32 s64, s47, s7
    buffer_load_dwordx4 v7, s[32:35], s64 offen sc1 lds
    s_add_u32 m0, s69, 34816
    s_add_u32 s64, s48, s7
    buffer_load_dwordx4 v7, s[32:35], s64 offen sc1 lds
    s_add_u32 m0, s69, 35840
    s_add_u32 s64, s49, s7
    buffer_load_dwordx4 v7, s[32:35], s64 offen sc1 lds
    s_waitcnt vmcnt(4)
    s_barrier
    s_add_u32 s7, s6, 12
    s_sub_u32 s65, s7, 14
    s_cmp_ge_u32 s7, 14
    s_cselect_b32 s7, s65, s7
    s_lshl_b32 s7, s7, 10
    s_add_u32 m0, s69, 0
    s_add_u32 s64, s46, s7
    buffer_load_dwordx4 v7, s[32:35], s64 offen sc1 lds
    s_add_u32 m0, s69, 1024
    s_add_u32 s64, s47, s7
    buffer_load_dwordx4 v7, s[32:35], s64 offen sc1 lds
    s_add_u32 m0, s69, 2048
    s_add_u32 s64, s48, s7
    buffer_load_dwordx4 v7, s[32:35], s64 offen sc1 lds
    s_add_u32 m0, s69, 3072
    s_add_u32 s64, s49, s7
    buffer_load_dwordx4 v7, s[32:35], s64 offen sc1 lds
    s_waitcnt vmcnt(4)
    s_barrier
    s_add_u32 s7, s6, 13
    s_sub_u32 s65, s7, 14
    s_cmp_ge_u32 s7, 14
    s_cselect_b32 s7, s65, s7
    s_lshl_b32 s7, s7, 10
    s_add_u32 m0, s69, 16384
    s_add_u32 s64, s46, s7
    buffer_load_dwordx4 v7, s[32:35], s64 offen sc1 lds
    s_add_u32 m0, s69, 17408
    s_add_u32 s64, s47, s7
    buffer_load_dwordx4 v7, s[32:35], s64 offen sc1 lds
    s_add_u32 m0, s69, 18432
    s_add_u32 s64, s48, s7
    buffer_load_dwordx4 v7, s[32:35], s64 offen sc1 lds
    s_add_u32 m0, s69, 19456
    s_add_u32 s64, s49, s7
    buffer_load_dwordx4 v7, s[32:35], s64 offen sc1 lds
    s_waitcnt vmcnt(4)
    s_barrier
    s_waitcnt vmcnt(0)
    s_barrier
    s_barrier
    s_barrier
    s_endpgm
L_teamB:
    s_add_u32 s66, s45, 1
    s_and_b32 s66, s66, 7
    s_lshl_b32 s65, s66, 7
    s_add_u32 s65, s65, s53
    s_mul_i32 s66, s66, 196608
    s_add_u32 s66, s66, s55
    s_add_u32 m0, s59, 65536
    s_add_u32 s64, s66, 1024
    buffer_load_dwordx4 v15, s[12:15], s64 offen lds
    s_add_u32 m0, s59, 69632
    s_add_u32 s64, s66, 2048
    buffer_load_dwordx4 v15, s[12:15], s64 offen lds
    s_add_u32 m0, s59, 61440
    s_add_u32 s64, s66, 0
    buffer_load_dwordx4 v15, s[12:15], s64 offen lds
    s_add_u32 m0, s59, 45056
    s_add_u32 s64, s65, 0
    buffer_load_dwordx4 v14, s[8:11], s64 offen lds
    s_add_u32 m0, s59, 49152
    s_add_u32 s64, s65, 32768
    buffer_load_dwordx4 v14, s[8:11], s64 offen lds
    s_add_u32 m0, s59, 53248
    s_add_u32 s64, s65, 65536
    buffer_load_dwordx4 v14, s[8:11], s64 offen lds
    s_add_u32 m0, s59, 57344
    s_add_u32 s64, s65, 98304
    buffer_load_dwordx4 v14, s[8:11], s64 offen lds
    s_add_u32 s66, s45, 2
    s_and_b32 s66, s66, 7
    s_lshl_b32 s65, s66, 7
    s_add_u32 s65, s65, s53
    s_mul_i32 s66, s66, 196608
    s_add_u32 s66, s66, s55
    s_add_u32 m0, s59, 94208
    s_add_u32 s64, s66, 1024
    buffer_load_dwordx4 v15, s[12:15], s64 offen lds
    s_add_u32 m0, s59, 98304
    s_add_u32 s64, s66, 2048
    buffer_load_dwordx4 v15, s[12:15], s64 offen lds
    s_add_u32 m0, s59, 90112
    s_add_u32 s64, s66, 0
    buffer_load_dwordx4 v15, s[12:15], s64 offen lds
    s_add_u32 m0, s59, 73728
    s_add_u32 s64, s65, 0
    buffer_load_dwordx4 v14, s[8:11], s64 offen lds
    s_add_u32 m0, s59, 77824
    s_add_u32 s64, s65, 32768
    buffer_load_dwordx4 v14, s[8:11], s64 offen lds
    s_add_u32 m0, s59, 81920
    s_add_u32 s64, s65, 65536
    buffer_load_dwordx4 v14, s[8:11], s64 offen lds
    s_add_u32 m0, s59, 86016
    s_add_u32 s64, s65, 98304
    buffer_load_dwordx4 v14, s[8:11], s64 offen lds
    s_mov_b32 s32, s38
    s_mov_b32 s33, s39
    s_mov_b32 s34, 16777216
    s_mov_b32 s35, 0x20000
    s_mov_b32 s16, s76
    s_mov_b32 s17, s77
    s_mov_b32 s18, 524288
    s_mov_b32 s19, 0x20000
    s_mov_b32 s20, s80
    s_mov_b32 s21, s81
    s_mov_b32 s22, 1835008
    s_mov_b32 s23, 0x20000
    s_mov_b32 s24, s82
    s_mov_b32 s25, s83
    s_mov_b32 s26, 1835008
    s_mov_b32 s27, 0x20000
    s_mov_b32 s28, s84
    s_mov_b32 s29, s85
    s_mov_b32 s30, 2097152
    s_mov_b32 s31, 0x20000
    s_movk_i32 s46, 4682
    s_movk_i32 s47, 3584
    v_add_u32 v4, 0, v1
    v_mul_lo_u32 v5, v4, s46
    v_lshrrev_b32 v5, 16, v5
    v_mul_u32_u24 v18, 14, v5
    v_sub_u32 v18, v4, v18
    v_mul_lo_u32 v5, v5, s47
    v_lshl_add_u32 v18, v18, 4, v5
    v_add_u32 v4, 64, v1
    v_mul_lo_u32 v5, v4, s46
    v_lshrrev_b32 v5, 16, v5
    v_mul_u32_u24 v19, 14, v5
    v_sub_u32 v19, v4, v19
    v_mul_lo_u32 v5, v5, s47
    v_lshl_add_u32 v19, v19, 4, v5
    v_add_u32 v4, 128, v1
    v_mul_lo_u32 v5, v4, s46
    v_lshrrev_b32 v5, 16, v5
    v_mul_u32_u24 v20, 14, v5
    v_sub_u32 v20, v4, v20
    v_mul_lo_u32 v5, v5, s47
    v_lshl_add_u32 v20, v20, 4, v5
    v_add_u32 v4, 192, v1
    v_mul_lo_u32 v5, v4, s46
    v_lshrrev_b32 v5, 16, v5
    v_mul_u32_u24 v21, 14, v5
    v_sub_u32 v21, v4, v21
    v_mul_lo_u32 v5, v5, s47
    v_lshl_add_u32 v21, v21, 4, v5
    v_add_u32 v4, 256, v1
    v_mul_lo_u32 v5, v4, s46
    v_lshrrev_b32 v5, 16, v5
    v_mul_u32_u24 v22, 14, v5
    v_sub_u32 v22, v4, v22
    v_mul_lo_u32 v5, v5, s47
    v_lshl_add_u32 v22, v22, 4, v5
    v_add_u32 v4, 320, v1
    v_mul_lo_u32 v5, v4, s46
    v_lshrrev_b32 v5, 16, v5
    v_mul_u32_u24 v23, 14, v5
    v_sub_u32 v23, v4, v23
    v_mul_lo_u32 v5, v5, s47
    v_lshl_add_u32 v23, v23, 4, v5
    v_add_u32 v4, 384, v1
    v_mul_lo_u32 v5, v4, s46
    v_lshrrev_b32 v5, 16, v5
    v_mul_u32_u24 v24, 14, v5
    v_sub_u32 v24, v4, v24
    v_mul_lo_u32 v5, v5, s47
    v_lshl_add_u32 v24, v24, 4, v5
    s_mul_i32 s67, s41, 224
    s_mul_i32 s68, s44, 7168
    v_lshrrev_b32 v4, 1, v2
    v_xor_b32 v4, v4, v3
    v_lshlrev_b32 v4, 4, v4
    v_lshl_add_u32 v27, v2, 7, v4
    v_xor_b32 v28, 64, v27
    v_lshrrev_b32 v4, 2, v2
    v_lshl_add_u32 v4, v3, 3, v4
    v_lshlrev_b32 v4, 6, v4
    v_and_b32 v5, 3, v1
    v_lshl_add_u32 v4, v5, 3, v4
    v_and_b32 v5, 1, v3
    s_mul_i32 s46, s61, 3
    s_add_u32 s46, s46, 0
    s_and_b32 s47, s46, 1
    s_lshr_b32 s46, s46, 1
    s_lshl_b32 s46, s46, 12
    s_lshl_b32 s48, s60, 11
    s_add_u32 s46, s46, s48
    v_xor_b32 v6, s47, v5
    v_lshl_add_u32 v6, v6, 5, v4
    v_add_u32 v40, s46, v6
    s_mul_i32 s46, s61, 3
    s_add_u32 s46, s46, 1
    s_and_b32 s47, s46, 1
    s_lshr_b32 s46, s46, 1
    s_lshl_b32 s46, s46, 12
    s_lshl_b32 s48, s60, 11
    s_add_u32 s46, s46, s48
    v_xor_b32 v6, s47, v5
    v_lshl_add_u32 v6, v6, 5, v4
    v_add_u32 v41, s46, v6
    s_mul_i32 s46, s61, 3
    s_add_u32 s46, s46, 2
    s_and_b32 s47, s46, 1
    s_lshr_b32 s46, s46, 1
    s_lshl_b32 s46, s46, 12
    s_lshl_b32 s48, s60, 11
    s_add_u32 s46, s46, s48
    v_xor_b32 v6, s47, v5
    v_lshl_add_u32 v6, v6, 5, v4
    v_add_u32 v42, s46, v6
    s_setprio 3
    s_barrier
    s_lshl_b32 s46, s44, 12
    s_add_u32 s46, s46, 16384
    v_add_u32 v25, s46, v27
    v_add_u32 v26, s46, v28
    ds_read_b128 v[44:47], v25 offset:0
    ds_read_b128 v[48:51], v26 offset:0
    ds_read_b128 v[52:55], v25 offset:2048
    ds_read_b128 v[56:59], v26 offset:2048
    v_add_u32 v4, 32768, v40
    ds_read_b64_tr_b16 v[76:77], v4 offset:0
    ds_read_b64_tr_b16 v[78:79], v4 offset:256
    v_add_u32 v4, 32768, v41
    ds_read_b64_tr_b16 v[80:81], v4 offset:0
    ds_read_b64_tr_b16 v[82:83], v4 offset:256
    v_add_u32 v4, 32768, v42
    ds_read_b64_tr_b16 v[84:85], v4 offset:0
    ds_read_b64_tr_b16 v[86:87], v4 offset:256
    s_add_u32 s66, s45, 3
    s_and_b32 s66, s66, 7
    s_lshl_b32 s65, s66, 7
    s_add_u32 s65, s65, s53
    s_mul_i32 s66, s66, 196608
    s_add_u32 s66, s66, s55
    s_add_u32 m0, s59, 122880
    s_add_u32 s64, s66, 1024
    buffer_load_dwordx4 v15, s[12:15], s64 offen lds
    s_waitcnt lgkmcnt(0)
    v_mfma_f32_16x16x32_bf16 v[60:63], v[10:13], v[44:47], 0
    v_mfma_f32_16x16x32_bf16 v[64:67], v[44:47], v[44:47], 0
    s_add_u32 m0, s59, 126976
    s_add_u32 s64, s66, 2048
    buffer_load_dwordx4 v15, s[12:15], s64 offen lds
    v_mfma_f32_16x16x32_bf16 v[68:71], v[10:13], v[52:55], 0
    v_mfma_f32_16x16x32_bf16 v[72:75], v[52:55], v[52:55], 0
    s_add_u32 m0, s59, 118784
    s_add_u32 s64, s66, 0
    buffer_load_dwordx4 v15, s[12:15], s64 offen lds
    v_mfma_f32_16x16x32_bf16 v[60:63], v[10:13], v[48:51], v[60:63]
    v_mfma_f32_16x16x32_bf16 v[64:67], v[48:51], v[48:51], v[64:67]
    s_add_u32 m0, s59, 102400
    s_add_u32 s64, s65, 0
    buffer_load_dwordx4 v14, s[8:11], s64 offen lds
    v_mfma_f32_16x16x32_bf16 v[68:71], v[10:13], v[56:59], v[68:71]
    v_mfma_f32_16x16x32_bf16 v[72:75], v[56:59], v[56:59], v[72:75]
    s_add_u32 m0, s59, 106496
    s_add_u32 s64, s65, 32768
    buffer_load_dwordx4 v14, s[8:11], s64 offen lds
    v_mfma_f32_16x16x32_bf16 v[88:91], v[76:79], v[10:13], 0
    v_mfma_f32_16x16x32_bf16 v[92:95], v[80:83], v[10:13], 0
    s_add_u32 m0, s59, 110592
    s_add_u32 s64, s65, 65536
    buffer_load_dwordx4 v14, s[8:11], s64 offen lds
    v_mfma_f32_16x16x32_bf16 v[96:99], v[84:87], v[10:13], 0
    s_add_u32 m0, s59, 114688
    s_add_u32 s64, s65, 98304
    buffer_load_dwordx4 v14, s[8:11], s64 offen lds
    s_add_u32 s66, s45, 4
    s_and_b32 s66, s66, 7
    s_lshl_b32 s65, s66, 7
    s_add_u32 s65, s65, s53
    s_mul_i32 s66, s66, 196608
    s_add_u32 s66, s66, s55
    s_add_u32 m0, s59, 151552
    s_add_u32 s64, s66, 1024
    buffer_load_dwordx4 v15, s[12:15], s64 offen lds
    s_add_u32 m0, s59, 155648
    s_add_u32 s64, s66, 2048
    buffer_load_dwordx4 v15, s[12:15], s64 offen lds
    s_add_u32 m0, s59, 147456
    s_add_u32 s64, s66, 0
    buffer_load_dwordx4 v15, s[12:15], s64 offen lds
    s_add_u32 m0, s59, 131072
    s_add_u32 s64, s65, 0
    buffer_load_dwordx4 v14, s[8:11], s64 offen lds
    s_add_u32 m0, s59, 135168
    s_add_u32 s64, s65, 32768
    buffer_load_dwordx4 v14, s[8:11], s64 offen lds
    s_add_u32 m0, s59, 139264
    s_add_u32 s64, s65, 65536
    buffer_load_dwordx4 v14, s[8:11], s64 offen lds
    s_add_u32 m0, s59, 143360
    s_add_u32 s64, s65, 98304
    buffer_load_dwordx4 v14, s[8:11], s64 offen lds
    s_lshl_b32 s46, s44, 12
    v_add_u32 v25, s46, v27
    v_add_u32 v26, s46, v28
    ds_read_b128 v[100:103], v25 offset:0
    ds_read_b128 v[104:107], v26 offset:0
    ds_read_b128 v[108:111], v25 offset:2048
    ds_read_b128 v[112:115], v26 offset:2048
    s_waitcnt lgkmcnt(0)
    v_mfma_f32_16x16x32_bf16 v[116:119], v[10:13], v[100:103], 0
    v_mfma_f32_16x16x32_bf16 v[120:123], v[100:103], v[100:103], 0
    v_mfma_f32_16x16x32_bf16 v[116:119], v[10:13], v[104:107], v[116:119]
    v_mfma_f32_16x16x32_bf16 v[120:123], v[104:107], v[104:107], v[120:123]
    v_mfma_f32_16x16x32_bf16 v[116:119], v[10:13], v[108:111], v[116:119]
    v_mfma_f32_16x16x32_bf16 v[120:123], v[108:111], v[108:111], v[120:123]
    v_mfma_f32_16x16x32_bf16 v[116:119], v[10:13], v[112:115], v[116:119]
    v_mfma_f32_16x16x32_bf16 v[120:123], v[112:115], v[112:115], v[120:123]
    v_and_b32 v6, 3, v2
    v_cmp_eq_u32 vcc, 1, v6
    s_nop 5
    v_cndmask_b32 v120, v120, v121, vcc
    v_cmp_eq_u32 vcc, 2, v6
    s_nop 1
    v_cndmask_b32 v120, v120, v122, vcc
    v_cmp_eq_u32 vcc, 3, v6
    s_nop 1
    v_cndmask_b32 v120, v120, v123, vcc
    s_lshl_b32 s48, s44, 7
    s_add_u32 s48, s48, 161664
    v_lshlrev_b32 v4, 3, v2
    v_add_u32 v4, s48, v4
    ds_write_b32 v4, v116
    s_mov_b32 s46, 0xf0000f
    s_mov_b32 s47, 0xf0000f00
    s_mov_b64 exec, s[46:47]
    ds_write_b32 v4, v120 offset:4
    s_mov_b64 exec, -1
    s_waitcnt vmcnt(21)
    s_waitcnt lgkmcnt(0)
    s_barrier
    s_lshl_b32 s46, s44, 12
    s_add_u32 s46, s46, 45056
    v_add_u32 v25, s46, v27
    v_add_u32 v26, s46, v28
    ds_read_b128 v[44:47], v25 offset:0
    ds_read_b128 v[48:51], v26 offset:0
    ds_read_b128 v[52:55], v25 offset:2048
    ds_read_b128 v[56:59], v26 offset:2048
    v_add_u32 v4, 61440, v40
    ds_read_b64_tr_b16 v[76:77], v4 offset:0
    ds_read_b64_tr_b16 v[78:79], v4 offset:256
    v_add_u32 v4, 61440, v41
    ds_read_b64_tr_b16 v[80:81], v4 offset:0
    ds_read_b64_tr_b16 v[82:83], v4 offset:256
    v_add_u32 v4, 61440, v42
    ds_read_b64_tr_b16 v[84:85], v4 offset:0
    ds_read_b64_tr_b16 v[86:87], v4 offset:256
    s_add_u32 s66, s45, 5
    s_and_b32 s66, s66, 7
    s_lshl_b32 s65, s66, 7
    s_add_u32 s65, s65, s53
    s_mul_i32 s66, s66, 196608
    s_add_u32 s66, s66, s55
    s_add_u32 m0, s59, 36864
    s_add_u32 s64, s66, 1024
    buffer_load_dwordx4 v15, s[12:15], s64 offen lds
    s_waitcnt lgkmcnt(0)
    v_mfma_f32_16x16x32_bf16 v[60:63], v[10:13], v[44:47], v[60:63]
    v_mfma_f32_16x16x32_bf16 v[64:67], v[44:47], v[44:47], v[64:67]
    s_add_u32 m0, s59, 40960
    s_add_u32 s64, s66, 2048
    buffer_load_dwordx4 v15, s[12:15], s64 offen lds
    v_mfma_f32_16x16x32_bf16 v[68:71], v[10:13], v[52:55], v[68:71]
    v_mfma_f32_16x16x32_bf16 v[72:75], v[52:55], v[52:55], v[72:75]
    s_add_u32 m0, s59, 32768
    s_add_u32 s64, s66, 0
    buffer_load_dwordx4 v15, s[12:15], s64 offen lds
    v_mfma_f32_16x16x32_bf16 v[60:63], v[10:13], v[48:51], v[60:63]
    v_mfma_f32_16x16x32_bf16 v[64:67], v[48:51], v[48:51], v[64:67]
    s_add_u32 m0, s59, 16384
    s_add_u32 s64, s65, 0
    buffer_load_dwordx4 v14, s[8:11], s64 offen lds
    v_mfma_f32_16x16x32_bf16 v[68:71], v[10:13], v[56:59], v[68:71]
    v_mfma_f32_16x16x32_bf16 v[72:75], v[56:59], v[56:59], v[72:75]
    s_add_u32 m0, s59, 20480
    s_add_u32 s64, s65, 32768
    buffer_load_dwordx4 v14, s[8:11], s64 offen lds
    v_mfma_f32_16x16x32_bf16 v[88:91], v[76:79], v[10:13], v[88:91]
    v_mfma_f32_16x16x32_bf16 v[92:95], v[80:83], v[10:13], v[92:95]
    s_add_u32 m0, s59, 24576
    s_add_u32 s64, s65, 65536
    buffer_load_dwordx4 v14, s[8:11], s64 offen lds
    v_mfma_f32_16x16x32_bf16 v[96:99], v[84:87], v[10:13], v[96:99]
    s_add_u32 m0, s59, 28672
    s_add_u32 s64, s65, 98304
    buffer_load_dwordx4 v14, s[8:11], s64 offen lds
    s_waitcnt vmcnt(21)
    s_waitcnt lgkmcnt(0)
    s_barrier
    s_lshl_b32 s46, s44, 12
    s_add_u32 s46, s46, 73728
    v_add_u32 v25, s46, v27
    v_add_u32 v26, s46, v28
    ds_read_b128 v[44:47], v25 offset:0
    ds_read_b128 v[48:51], v26 offset:0
    ds_read_b128 v[52:55], v25 offset:2048
    ds_read_b128 v[56:59], v26 offset:2048
    v_add_u32 v4, 90112, v40
    ds_read_b64_tr_b16 v[76:77], v4 offset:0
    ds_read_b64_tr_b16 v[78:79], v4 offset:256
    v_add_u32 v4, 90112, v41
    ds_read_b64_tr_b16 v[80:81], v4 offset:0
    ds_read_b64_tr_b16 v[82:83], v4 offset:256
    v_add_u32 v4, 90112, v42
    ds_read_b64_tr_b16 v[84:85], v4 offset:0
    ds_read_b64_tr_b16 v[86:87], v4 offset:256
    s_add_u32 s66, s45, 6
    s_and_b32 s66, s66, 7
    s_lshl_b32 s65, s66, 7
    s_add_u32 s65, s65, s53
    s_mul_i32 s66, s66, 196608
    s_add_u32 s66, s66, s55
    s_add_u32 m0, s59, 65536
    s_add_u32 s64, s66, 1024
    buffer_load_dwordx4 v15, s[12:15], s64 offen lds
    s_waitcnt lgkmcnt(0)
    v_mfma_f32_16x16x32_bf16 v[60:63], v[10:13], v[44:47], v[60:63]
    v_mfma_f32_16x16x32_bf16 v[64:67], v[44:47], v[44:47], v[64:67]
    s_add_u32 m0, s59, 69632
    s_add_u32 s64, s66, 2048
    buffer_load_dwordx4 v15, s[12:15], s64 offen lds
    v_mfma_f32_16x16x32_bf16 v[68:71], v[10:13], v[52:55], v[68:71]
    v_mfma_f32_16x16x32_bf16 v[72:75], v[52:55], v[52:55], v[72:75]
    s_add_u32 m0, s59, 61440
    s_add_u32 s64, s66, 0
    buffer_load_dwordx4 v15, s[12:15], s64 offen lds
    v_mfma_f32_16x16x32_bf16 v[60:63], v[10:13], v[48:51], v[60:63]
    v_mfma_f32_16x16x32_bf16 v[64:67], v[48:51], v[48:51], v[64:67]
    s_add_u32 m0, s59, 45056
    s_add_u32 s64, s65, 0
    buffer_load_dwordx4 v14, s[8:11], s64 offen lds
    v_mfma_f32_16x16x32_bf16 v[68:71], v[10:13], v[56:59], v[68:71]
    v_mfma_f32_16x16x32_bf16 v[72:75], v[56:59], v[56:59], v[72:75]
    s_add_u32 m0, s59, 49152
    s_add_u32 s64, s65, 32768
    buffer_load_dwordx4 v14, s[8:11], s64 offen lds
    v_mfma_f32_16x16x32_bf16 v[88:91], v[76:79], v[10:13], v[88:91]
    v_mfma_f32_16x16x32_bf16 v[92:95], v[80:83], v[10:13], v[92:95]
    s_add_u32 m0, s59, 53248
    s_add_u32 s64, s65, 65536
    buffer_load_dwordx4 v14, s[8:11], s64 offen lds
    v_mfma_f32_16x16x32_bf16 v[96:99], v[84:87], v[10:13], v[96:99]
    s_add_u32 m0, s59, 57344
    s_add_u32 s64, s65, 98304
    buffer_load_dwordx4 v14, s[8:11], s64 offen lds
    v_lshlrev_b32 v4, 3, v2
    v_add_u32 v4, 161664, v4
    ds_read_b64 v[100:101], v4 offset:0
    ds_read_b64 v[102:103], v4 offset:128
    ds_read_b64 v[104:105], v4 offset:256
    ds_read_b64 v[106:107], v4 offset:384
    s_waitcnt lgkmcnt(0)
    v_add_f32 v100, v100, v102
    v_add_f32 v104, v104, v106
    v_add_f32 v101, v101, v103
    v_add_f32 v105, v105, v107
    v_add_f32 v100, v100, v104
    v_add_f32 v101, v101, v105
    v_lshlrev_b32 v4, 3, v2
    v_add_u32 v4, 159744, v4
    ds_write_b64 v4, v[100:101]
    s_waitcnt vmcnt(21)
    s_waitcnt lgkmcnt(0)
    s_barrier
    s_lshl_b32 s46, s44, 12
    s_add_u32 s46, s46, 102400
    v_add_u32 v25, s46, v27
    v_add_u32 v26, s46, v28
    ds_read_b128 v[44:47], v25 offset:0
    ds_read_b128 v[48:51], v26 offset:0
    ds_read_b128 v[52:55], v25 offset:2048
    ds_read_b128 v[56:59], v26 offset:2048
    v_add_u32 v4, 118784, v40
    ds_read_b64_tr_b16 v[76:77], v4 offset:0
    ds_read_b64_tr_b16 v[78:79], v4 offset:256
    v_add_u32 v4, 118784, v41
    ds_read_b64_tr_b16 v[80:81], v4 offset:0
    ds_read_b64_tr_b16 v[82:83], v4 offset:256
    v_add_u32 v4, 118784, v42
    ds_read_b64_tr_b16 v[84:85], v4 offset:0
    ds_read_b64_tr_b16 v[86:87], v4 offset:256
    s_add_u32 s66, s45, 7
    s_and_b32 s66, s66, 7
    s_lshl_b32 s65, s66, 7
    s_add_u32 s65, s65, s53
    s_mul_i32 s66, s66, 196608
    s_add_u32 s66, s66, s55
    s_add_u32 m0, s59, 94208
    s_add_u32 s64, s66, 1024
    buffer_load_dwordx4 v15, s[12:15], s64 offen lds
    s_waitcnt lgkmcnt(0)
    v_mfma_f32_16x16x32_bf16 v[60:63], v[10:13], v[44:47], v[60:63]
    v_mfma_f32_16x16x32_bf16 v[64:67], v[44:47], v[44:47], v[64:67]
    s_add_u32 m0, s59, 98304
    s_add_u32 s64, s66, 2048
    buffer_load_dwordx4 v15, s[12:15], s64 offen lds
    v_mfma_f32_16x16x32_bf16 v[68:71], v[10:13], v[52:55], v[68:71]
    v_mfma_f32_16x16x32_bf16 v[72:75], v[52:55], v[52:55], v[72:75]
    s_add_u32 m0, s59, 90112
    s_add_u32 s64, s66, 0
    buffer_load_dwordx4 v15, s[12:15], s64 offen lds
    v_mfma_f32_16x16x32_bf16 v[60:63], v[10:13], v[48:51], v[60:63]
    v_mfma_f32_16x16x32_bf16 v[64:67], v[48:51], v[48:51], v[64:67]
    s_add_u32 m0, s59, 73728
    s_add_u32 s64, s65, 0
    buffer_load_dwordx4 v14, s[8:11], s64 offen lds
    v_mfma_f32_16x16x32_bf16 v[68:71], v[10:13], v[56:59], v[68:71]
    v_mfma_f32_16x16x32_bf16 v[72:75], v[56:59], v[56:59], v[72:75]
    s_add_u32 m0, s59, 77824
    s_add_u32 s64, s65, 32768
    buffer_load_dwordx4 v14, s[8:11], s64 offen lds
    v_mfma_f32_16x16x32_bf16 v[88:91], v[76:79], v[10:13], v[88:91]
    v_mfma_f32_16x16x32_bf16 v[92:95], v[80:83], v[10:13], v[92:95]
    s_add_u32 m0, s59, 81920
    s_add_u32 s64, s65, 65536
    buffer_load_dwordx4 v14, s[8:11], s64 offen lds
    v_mfma_f32_16x16x32_bf16 v[96:99], v[84:87], v[10:13], v[96:99]
    s_add_u32 m0, s59, 86016
    s_add_u32 s64, s65, 98304
    buffer_load_dwordx4 v14, s[8:11], s64 offen lds
    s_waitcnt vmcnt(21)
    s_waitcnt lgkmcnt(0)
    s_barrier
    s_lshl_b32 s46, s44, 12
    s_add_u32 s46, s46, 131072
    v_add_u32 v25, s46, v27
    v_add_u32 v26, s46, v28
    ds_read_b128 v[44:47], v25 offset:0
    ds_read_b128 v[48:51], v26 offset:0
    ds_read_b128 v[52:55], v25 offset:2048
    ds_read_b128 v[56:59], v26 offset:2048
    v_add_u32 v4, 147456, v40
    ds_read_b64_tr_b16 v[76:77], v4 offset:0
    ds_read_b64_tr_b16 v[78:79], v4 offset:256
    v_add_u32 v4, 147456, v41
    ds_read_b64_tr_b16 v[80:81], v4 offset:0
    ds_read_b64_tr_b16 v[82:83], v4 offset:256
    v_add_u32 v4, 147456, v42
    ds_read_b64_tr_b16 v[84:85], v4 offset:0
    ds_read_b64_tr_b16 v[86:87], v4 offset:256
    s_waitcnt lgkmcnt(0)
    v_mfma_f32_16x16x32_bf16 v[60:63], v[10:13], v[44:47], v[60:63]
    v_mfma_f32_16x16x32_bf16 v[64:67], v[44:47], v[44:47], v[64:67]
    v_mfma_f32_16x16x32_bf16 v[68:71], v[10:13], v[52:55], v[68:71]
    v_mfma_f32_16x16x32_bf16 v[72:75], v[52:55], v[52:55], v[72:75]
    v_mfma_f32_16x16x32_bf16 v[60:63], v[10:13], v[48:51], v[60:63]
    v_mfma_f32_16x16x32_bf16 v[64:67], v[48:51], v[48:51], v[64:67]
    v_mfma_f32_16x16x32_bf16 v[68:71], v[10:13], v[56:59], v[68:71]
    v_mfma_f32_16x16x32_bf16 v[72:75], v[56:59], v[56:59], v[72:75]
    v_mfma_f32_16x16x32_bf16 v[88:91], v[76:79], v[10:13], v[88:91]
    v_mfma_f32_16x16x32_bf16 v[92:95], v[80:83], v[10:13], v[92:95]
    v_mfma_f32_16x16x32_bf16 v[96:99], v[84:87], v[10:13], v[96:99]
    v_bfe_u32 v4, v1, 3, 1
    v_lshlrev_b32 v4, 14, v4
    v_and_b32 v5, 7, v1
    v_lshl_add_u32 v4, v5, 7, v4
    s_lshl_b32 s46, s40, 3
    s_lshl_b32 s47, s44, 1
    s_add_u32 s46, s46, s47
    s_lshl_b32 s46, s46, 14
    s_lshl_b32 s47, s41, 10
    s_add_u32 s46, s46, s47
    s_mov_b64 exec, 0xffff
    buffer_load_dword v29, v4, s[32:35], s46 offen
    s_mov_b64 exec, -1
    s_waitcnt vmcnt(15)
    s_waitcnt lgkmcnt(0)
    s_barrier
    s_lshl_b32 s46, s44, 12
    s_add_u32 s46, s46, 16384
    v_add_u32 v25, s46, v27
    v_add_u32 v26, s46, v28
    ds_read_b128 v[44:47], v25 offset:0
    ds_read_b128 v[48:51], v26 offset:0
    ds_read_b128 v[52:55], v25 offset:2048
    ds_read_b128 v[56:59], v26 offset:2048
    v_add_u32 v4, 32768, v40
    ds_read_b64_tr_b16 v[76:77], v4 offset:0
    ds_read_b64_tr_b16 v[78:79], v4 offset:256
    v_add_u32 v4, 32768, v41
    ds_read_b64_tr_b16 v[80:81], v4 offset:0
    ds_read_b64_tr_b16 v[82:83], v4 offset:256
    v_add_u32 v4, 32768, v42
    ds_read_b64_tr_b16 v[84:85], v4 offset:0
    ds_read_b64_tr_b16 v[86:87], v4 offset:256
    s_waitcnt lgkmcnt(0)
    v_mfma_f32_16x16x32_bf16 v[60:63], v[10:13], v[44:47], v[60:63]
    v_mfma_f32_16x16x32_bf16 v[64:67], v[44:47], v[44:47], v[64:67]
    v_mfma_f32_16x16x32_bf16 v[68:71], v[10:13], v[52:55], v[68:71]
    v_mfma_f32_16x16x32_bf16 v[72:75], v[52:55], v[52:55], v[72:75]
    v_mfma_f32_16x16x32_bf16 v[60:63], v[10:13], v[48:51], v[60:63]
    v_mfma_f32_16x16x32_bf16 v[64:67], v[48:51], v[48:51], v[64:67]
    v_mfma_f32_16x16x32_bf16 v[68:71], v[10:13], v[56:59], v[68:71]
    v_mfma_f32_16x16x32_bf16 v[72:75], v[56:59], v[56:59], v[72:75]
    v_mfma_f32_16x16x32_bf16 v[88:91], v[76:79], v[10:13], v[88:91]
    v_mfma_f32_16x16x32_bf16 v[92:95], v[80:83], v[10:13], v[92:95]
    v_mfma_f32_16x16x32_bf16 v[96:99], v[84:87], v[10:13], v[96:99]
    s_waitcnt vmcnt(8)
    s_waitcnt lgkmcnt(0)
    s_barrier
    s_lshl_b32 s46, s44, 12
    s_add_u32 s46, s46, 45056
    v_add_u32 v25, s46, v27
    v_add_u32 v26, s46, v28
    ds_read_b128 v[44:47], v25 offset:0
    ds_read_b128 v[48:51], v26 offset:0
    ds_read_b128 v[52:55], v25 offset:2048
    ds_read_b128 v[56:59], v26 offset:2048
    v_add_u32 v4, 61440, v40
    ds_read_b64_tr_b16 v[76:77], v4 offset:0
    ds_read_b64_tr_b16 v[78:79], v4 offset:256
    v_add_u32 v4, 61440, v41
    ds_read_b64_tr_b16 v[80:81], v4 offset:0
    ds_read_b64_tr_b16 v[82:83], v4 offset:256
    v_add_u32 v4, 61440, v42
    ds_read_b64_tr_b16 v[84:85], v4 offset:0
    ds_read_b64_tr_b16 v[86:87], v4 offset:256
    s_waitcnt lgkmcnt(0)
    v_mfma_f32_16x16x32_bf16 v[60:63], v[10:13], v[44:47], v[60:63]
    v_mfma_f32_16x16x32_bf16 v[64:67], v[44:47], v[44:47], v[64:67]
    v_mfma_f32_16x16x32_bf16 v[68:71], v[10:13], v[52:55], v[68:71]
    v_mfma_f32_16x16x32_bf16 v[72:75], v[52:55], v[52:55], v[72:75]
    v_mfma_f32_16x16x32_bf16 v[60:63], v[10:13], v[48:51], v[60:63]
    v_mfma_f32_16x16x32_bf16 v[64:67], v[48:51], v[48:51], v[64:67]
    v_mfma_f32_16x16x32_bf16 v[68:71], v[10:13], v[56:59], v[68:71]
    v_mfma_f32_16x16x32_bf16 v[72:75], v[56:59], v[56:59], v[72:75]
    v_mfma_f32_16x16x32_bf16 v[88:91], v[76:79], v[10:13], v[88:91]
    v_mfma_f32_16x16x32_bf16 v[92:95], v[80:83], v[10:13], v[92:95]
    v_mfma_f32_16x16x32_bf16 v[96:99], v[84:87], v[10:13], v[96:99]
    s_waitcnt vmcnt(1)
    s_waitcnt lgkmcnt(0)
    s_barrier
    s_lshl_b32 s46, s44, 12
    s_add_u32 s46, s46, 73728
    v_add_u32 v25, s46, v27
    v_add_u32 v26, s46, v28
    ds_read_b128 v[44:47], v25 offset:0
    ds_read_b128 v[48:51], v26 offset:0
    ds_read_b128 v[52:55], v25 offset:2048
    ds_read_b128 v[56:59], v26 offset:2048
    v_add_u32 v4, 90112, v40
    ds_read_b64_tr_b16 v[76:77], v4 offset:0
    ds_read_b64_tr_b16 v[78:79], v4 offset:256
    v_add_u32 v4, 90112, v41
    ds_read_b64_tr_b16 v[80:81], v4 offset:0
    ds_read_b64_tr_b16 v[82:83], v4 offset:256
    v_add_u32 v4, 90112, v42
    ds_read_b64_tr_b16 v[84:85], v4 offset:0
    ds_read_b64_tr_b16 v[86:87], v4 offset:256
    s_waitcnt lgkmcnt(0)
    v_mfma_f32_16x16x32_bf16 v[60:63], v[10:13], v[44:47], v[60:63]
    v_mfma_f32_16x16x32_bf16 v[64:67], v[44:47], v[44:47], v[64:67]
    v_mfma_f32_16x16x32_bf16 v[68:71], v[10:13], v[52:55], v[68:71]
    v_mfma_f32_16x16x32_bf16 v[72:75], v[52:55], v[52:55], v[72:75]
    v_mfma_f32_16x16x32_bf16 v[60:63], v[10:13], v[48:51], v[60:63]
    v_mfma_f32_16x16x32_bf16 v[64:67], v[48:51], v[48:51], v[64:67]
    v_mfma_f32_16x16x32_bf16 v[68:71], v[10:13], v[56:59], v[68:71]
    v_mfma_f32_16x16x32_bf16 v[72:75], v[56:59], v[56:59], v[72:75]
    v_mfma_f32_16x16x32_bf16 v[88:91], v[76:79], v[10:13], v[88:91]
    v_mfma_f32_16x16x32_bf16 v[92:95], v[80:83], v[10:13], v[92:95]
    v_mfma_f32_16x16x32_bf16 v[96:99], v[84:87], v[10:13], v[96:99]
    s_nop 7
    s_nop 7
    v_and_b32 v6, 3, v2
    v_cmp_eq_u32 vcc, 1, v6
    s_nop 1
    v_cndmask_b32 v64, v64, v65, vcc
    v_cndmask_b32 v72, v72, v73, vcc
    v_cmp_eq_u32 vcc, 2, v6
    s_nop 1
    v_cndmask_b32 v64, v64, v66, vcc
    v_cndmask_b32 v72, v72, v74, vcc
    v_cmp_eq_u32 vcc, 3, v6
    s_nop 1
    v_cndmask_b32 v64, v64, v67, vcc
    v_cndmask_b32 v72, v72, v75, vcc
    s_lshl_b32 s48, s44, 8
    s_add_u32 s48, s48, 159872
    v_lshlrev_b32 v4, 3, v2
    v_add_u32 v4, s48, v4
    ds_write_b32 v4, v60 offset:0
    ds_write_b32 v4, v68 offset:128
    s_mov_b32 s46, 0xf0000f
    s_mov_b32 s47, 0xf0000f00
    s_mov_b64 exec, s[46:47]
    ds_write_b32 v4, v64 offset:4
    ds_write_b32 v4, v72 offset:132
    s_mov_b64 exec, -1
    s_mul_i32 s46, s60, 384
    s_mul_i32 s47, s61, 192
    s_add_u32 s46, s46, s47
    s_add_u32 s46, s46, 160896
    v_lshlrev_b32 v4, 4, v3
    v_add_u32 v4, s46, v4
    ds_write_b128 v4, v[88:91] offset:0
    ds_write_b128 v4, v[92:95] offset:64
    ds_write_b128 v4, v[96:99] offset:128
    s_waitcnt lgkmcnt(0)
    s_setprio 0
    s_barrier
    v_mov_b32 v6, 163816
    ds_read_b64 v[4:5], v6
    s_waitcnt lgkmcnt(0)
    v_readfirstlane_b32 s101, v4
    v_readfirstlane_b32 s99, v5
    s_lshl_b32 s69, s44, 17
    s_lshl_b32 s48, s56, 7
    s_add_u32 s69, s69, s48
    s_lshl_b32 s65, s44, 14
    s_add_u32 m0, s65, 8192
    s_add_u32 s64, s69, 0
    buffer_load_dwordx4 v9, s[16:19], s64 offen lds
    s_add_u32 m0, s65, 9216
    s_add_u32 s64, s69, 8192
    buffer_load_dwordx4 v9, s[16:19], s64 offen lds
    s_add_u32 m0, s65, 10240
    s_add_u32 s64, s69, 16384
    buffer_load_dwordx4 v9, s[16:19], s64 offen lds
    s_add_u32 m0, s65, 11264
    s_add_u32 s64, s69, 24576
    buffer_load_dwordx4 v9, s[16:19], s64 offen lds
    s_add_u32 m0, s65, 12288
    s_add_u32 s64, s69, 32768
    buffer_load_dwordx4 v9, s[16:19], s64 offen lds
    s_add_u32 m0, s65, 13312
    s_add_u32 s64, s69, 40960
    buffer_load_dwordx4 v9, s[16:19], s64 offen lds
    s_add_u32 m0, s65, 14336
    s_add_u32 s64, s69, 49152
    buffer_load_dwordx4 v9, s[16:19], s64 offen lds
    s_add_u32 m0, s65, 15360
    s_add_u32 s64, s69, 57344
    buffer_load_dwordx4 v9, s[16:19], s64 offen lds
    s_add_u32 m0, s65, 16384
    s_add_u32 s64, s69, 65536
    buffer_load_dwordx4 v9, s[16:19], s64 offen lds
    s_add_u32 m0, s65, 17408
    s_add_u32 s64, s69, 73728
    buffer_load_dwordx4 v9, s[16:19], s64 offen lds
    s_add_u32 m0, s65, 18432
    s_add_u32 s64, s69, 81920
    buffer_load_dwordx4 v9, s[16:19], s64 offen lds
    s_add_u32 m0, s65, 19456
    s_add_u32 s64, s69, 90112
    buffer_load_dwordx4 v9, s[16:19], s64 offen lds
    s_add_u32 m0, s65, 20480
    s_add_u32 s64, s69, 98304
    buffer_load_dwordx4 v9, s[16:19], s64 offen lds
    s_add_u32 m0, s65, 21504
    s_add_u32 s64, s69, 106496
    buffer_load_dwordx4 v9, s[16:19], s64 offen lds
    s_add_u32 m0, s65, 22528
    s_add_u32 s64, s69, 114688
    buffer_load_dwordx4 v9, s[16:19], s64 offen lds
    s_add_u32 m0, s65, 23552
    s_add_u32 s64, s69, 122880
    buffer_load_dwordx4 v9, s[16:19], s64 offen lds
    s_lshl_b32 s50, s3, 3
    s_lshl_b32 s51, s57, 2
    s_add_u32 s53, s50, s51
    s_add_u32 s62, s53, s44
    s_lshl_b32 s63, s62, 14
    s_lshl_b32 s47, s56, 7
    s_add_u32 s63, s63, s47
    v_lshlrev_b32 v44, 10, v2
    v_lshl_add_u32 v44, v3, 3, v44
    buffer_load_dwordx2 v[32:33], v44, s[8:11], s63 offen offset:0
    buffer_load_dwordx2 v[34:35], v44, s[8:11], s63 offen offset:32
    buffer_load_dwordx2 v[36:37], v44, s[8:11], s63 offen offset:64
    buffer_load_dwordx2 v[38:39], v44, s[8:11], s63 offen offset:96
    s_lshl_b32 s46, s44, 14
    s_add_u32 s46, s46, 8192
    v_lshrrev_b32 v4, 2, v2
    v_lshl_add_u32 v5, v3, 2, v4
    v_lshrrev_b32 v6, 1, v5
    v_and_b32 v6, 3, v6
    v_lshlrev_b32 v5, 7, v5
    v_lshl_add_u32 v5, v6, 5, v5
    v_and_b32 v6, 3, v1
    v_lshl_add_u32 v5, v6, 3, v5
    v_xor_b32 v40, 0, v5
    v_xor_b32 v41, 32, v5
    v_xor_b32 v42, 64, v5
    v_xor_b32 v43, 96, v5
    v_add_u32 v40, s46, v40
    v_add_u32 v41, s46, v41
    v_add_u32 v42, s46, v42
    v_add_u32 v43, s46, v43
    s_waitcnt vmcnt(4)
    ds_read_b64_tr_b16 v[48:49], v40 offset:0
    ds_read_b64_tr_b16 v[50:51], v40 offset:2048
    ds_read_b64_tr_b16 v[64:65], v41 offset:0
    ds_read_b64_tr_b16 v[66:67], v41 offset:2048
    ds_read_b64_tr_b16 v[80:81], v42 offset:0
    ds_read_b64_tr_b16 v[82:83], v42 offset:2048
    ds_read_b64_tr_b16 v[96:97], v43 offset:0
    ds_read_b64_tr_b16 v[98:99], v43 offset:2048
    ds_read_b64_tr_b16 v[52:53], v40 offset:4096
    ds_read_b64_tr_b16 v[54:55], v40 offset:6144
    ds_read_b64_tr_b16 v[68:69], v41 offset:4096
    ds_read_b64_tr_b16 v[70:71], v41 offset:6144
    ds_read_b64_tr_b16 v[84:85], v42 offset:4096
    ds_read_b64_tr_b16 v[86:87], v42 offset:6144
    ds_read_b64_tr_b16 v[100:101], v43 offset:4096
    ds_read_b64_tr_b16 v[102:103], v43 offset:6144
    ds_read_b64_tr_b16 v[56:57], v40 offset:8192
    ds_read_b64_tr_b16 v[58:59], v40 offset:10240
    ds_read_b64_tr_b16 v[72:73], v41 offset:8192
    ds_read_b64_tr_b16 v[74:75], v41 offset:10240
    ds_read_b64_tr_b16 v[88:89], v42 offset:8192
    ds_read_b64_tr_b16 v[90:91], v42 offset:10240
    ds_read_b64_tr_b16 v[104:105], v43 offset:8192
    ds_read_b64_tr_b16 v[106:107], v43 offset:10240
    ds_read_b64_tr_b16 v[60:61], v40 offset:12288
    ds_read_b64_tr_b16 v[62:63], v40 offset:14336
    ds_read_b64_tr_b16 v[76:77], v41 offset:12288
    ds_read_b64_tr_b16 v[78:79], v41 offset:14336
    ds_read_b64_tr_b16 v[92:93], v42 offset:12288
    ds_read_b64_tr_b16 v[94:95], v42 offset:14336
    ds_read_b64_tr_b16 v[108:109], v43 offset:12288
    ds_read_b64_tr_b16 v[110:111], v43 offset:14336
    s_waitcnt lgkmcnt(0)
    v_and_b32 v4, 15, v1
    v_lshlrev_b32 v4, 7, v4
    s_lshl_b32 s46, s62, 14
    s_lshl_b32 s47, s56, 11
    s_add_u32 s46, s46, s47
    s_add_u32 s46, s46, 2097152
    s_mov_b64 exec, 0xffff
    buffer_load_dword v29, v4, s[32:35], s46 offen
    s_lshl_b32 s46, s62, 10
    s_lshr_b32 s47, s56, 1
    s_lshl_b32 s47, s47, 8
    s_add_u32 s46, s46, s47
    s_add_u32 s46, s46, 12582912
    s_mov_b64 exec, 3
    buffer_load_dword v29, v4, s[32:35], s46 offen
    s_mov_b64 exec, -1
    s_barrier
    s_add_u32 s51, s44, 0
    s_and_b32 s51, s51, 3
    s_add_u32 s51, s51, s53
    s_lshl_b32 s46, s51, 14
    s_lshl_b32 s51, s44, 12
    s_add_u32 s46, s46, s51
    s_add_u32 s51, s44, 1
    s_and_b32 s51, s51, 3
    s_add_u32 s51, s51, s53
    s_lshl_b32 s47, s51, 14
    s_lshl_b32 s51, s44, 12
    s_add_u32 s47, s47, s51
    s_add_u32 s51, s44, 2
    s_and_b32 s51, s51, 3
    s_add_u32 s51, s51, s53
    s_lshl_b32 s48, s51, 14
    s_lshl_b32 s51, s44, 12
    s_add_u32 s48, s48, s51
    s_add_u32 s51, s44, 3
    s_and_b32 s51, s51, 3
    s_add_u32 s51, s51, s53
    s_lshl_b32 s49, s51, 14
    s_lshl_b32 s51, s44, 12
    s_add_u32 s49, s49, s51
    s_add_u32 s7, s44, s5
    s_add_u32 s7, s7, 4
    s_and_b32 s7, s7, 15
    s_mul_i32 s7, s7, 114688
    s_add_u32 s7, s7, s67
    s_add_u32 m0, s68, 77824
    s_add_u32 s64, s7, 0
    buffer_load_dwordx4 v18, s[20:23], s64 offen lds
    s_add_u32 m0, s68, 78848
    s_add_u32 s64, s7, 0
    buffer_load_dwordx4 v19, s[20:23], s64 offen lds
    s_add_u32 m0, s68, 79872
    s_add_u32 s64, s7, 0
    buffer_load_dwordx4 v20, s[20:23], s64 offen lds
    s_add_u32 m0, s68, 80896
    s_add_u32 s64, s7, 0
    buffer_load_dwordx4 v21, s[20:23], s64 offen lds
    s_add_u32 m0, s68, 81920
    s_add_u32 s64, s7, 0
    buffer_load_dwordx4 v22, s[20:23], s64 offen lds
    s_add_u32 m0, s68, 82944
    s_add_u32 s64, s7, 0
    buffer_load_dwordx4 v23, s[20:23], s64 offen lds
    s_add_u32 m0, s68, 83968
    s_add_u32 s64, s7, 0
    buffer_load_dwordx4 v24, s[20:23], s64 offen lds
    s_add_u32 s7, s44, s5
    s_add_u32 s7, s7, 8
    s_and_b32 s7, s7, 15
    s_mul_i32 s7, s7, 114688
    s_add_u32 s7, s7, s67
    s_add_u32 m0, s68, 106496
    s_add_u32 s64, s7, 0
    buffer_load_dwordx4 v18, s[20:23], s64 offen lds
    s_add_u32 m0, s68, 107520
    s_add_u32 s64, s7, 0
    buffer_load_dwordx4 v19, s[20:23], s64 offen lds
    s_add_u32 m0, s68, 108544
    s_add_u32 s64, s7, 0
    buffer_load_dwordx4 v20, s[20:23], s64 offen lds
    s_add_u32 m0, s68, 109568
    s_add_u32 s64, s7, 0
    buffer_load_dwordx4 v21, s[20:23], s64 offen lds
    s_add_u32 m0, s68, 110592
    s_add_u32 s64, s7, 0
    buffer_load_dwordx4 v22, s[20:23], s64 offen lds
    s_add_u32 m0, s68, 111616
    s_add_u32 s64, s7, 0
    buffer_load_dwordx4 v23, s[20:23], s64 offen lds
    s_add_u32 m0, s68, 112640
    s_add_u32 s64, s7, 0
    buffer_load_dwordx4 v24, s[20:23], s64 offen lds
    s_add_u32 s51, s44, 1
    s_and_b32 s51, s51, 3
    s_mul_i32 s51, s51, 12288
    s_add_u32 s51, s51, 0
    v_add_u32 v45, s51, v7
    s_add_u32 s51, s44, 2
    s_and_b32 s51, s51, 3
    s_mul_i32 s51, s51, 12288
    s_add_u32 s51, s51, 4096
    v_add_u32 v46, s51, v7
    s_add_u32 s51, s44, 3
    s_and_b32 s51, s51, 3
    s_mul_i32 s51, s51, 12288
    s_add_u32 s51, s51, 8192
    v_add_u32 v47, s51, v7
    s_mul_i32 s51, s44, 12288
    s_add_u32 s51, s51, 0
    v_add_u32 v31, s51, v7
    s_barrier
    buffer_load_dwordx4 v[112:115], v7, s[32:35], s46 offen offset:0 sc1
    buffer_load_dwordx4 v[128:131], v7, s[32:35], s47 offen offset:0 sc1
    buffer_load_dwordx4 v[144:147], v7, s[32:35], s48 offen offset:0 sc1
    buffer_load_dwordx4 v[160:163], v7, s[32:35], s49 offen offset:0 sc1
    buffer_load_dwordx4 v[116:119], v7, s[32:35], s46 offen offset:1024 sc1
    buffer_load_dwordx4 v[132:135], v7, s[32:35], s47 offen offset:1024 sc1
    buffer_load_dwordx4 v[148:151], v7, s[32:35], s48 offen offset:1024 sc1
    buffer_load_dwordx4 v[164:167], v7, s[32:35], s49 offen offset:1024 sc1
    buffer_load_dwordx4 v[120:123], v7, s[32:35], s46 offen offset:2048 sc1
    buffer_load_dwordx4 v[136:139], v7, s[32:35], s47 offen offset:2048 sc1
    buffer_load_dwordx4 v[152:155], v7, s[32:35], s48 offen offset:2048 sc1
    buffer_load_dwordx4 v[168:171], v7, s[32:35], s49 offen offset:2048 sc1
    buffer_load_dwordx4 v[124:127], v7, s[32:35], s46 offen offset:3072 sc1
    buffer_load_dwordx4 v[140:143], v7, s[32:35], s47 offen offset:3072 sc1
    buffer_load_dwordx4 v[156:159], v7, s[32:35], s48 offen offset:3072 sc1
    buffer_load_dwordx4 v[172:175], v7, s[32:35], s49 offen offset:3072 sc1
    s_waitcnt vmcnt(12)
    v_mfma_f32_16x16x32_bf16 v[180:183], v[48:51], v[128:131], 0
    v_mfma_f32_16x16x32_bf16 v[196:199], v[64:67], v[128:131], 0
    v_mfma_f32_16x16x32_bf16 v[212:215], v[80:83], v[128:131], 0
    v_mfma_f32_16x16x32_bf16 v[228:231], v[96:99], v[128:131], 0
    v_mfma_f32_16x16x32_bf16 v[184:187], v[48:51], v[144:147], 0
    v_mfma_f32_16x16x32_bf16 v[200:203], v[64:67], v[144:147], 0
    v_mfma_f32_16x16x32_bf16 v[216:219], v[80:83], v[144:147], 0
    v_mfma_f32_16x16x32_bf16 v[232:235], v[96:99], v[144:147], 0
    v_mfma_f32_16x16x32_bf16 v[188:191], v[48:51], v[160:163], 0
    v_mfma_f32_16x16x32_bf16 v[204:207], v[64:67], v[160:163], 0
    v_mfma_f32_16x16x32_bf16 v[220:223], v[80:83], v[160:163], 0
    v_mfma_f32_16x16x32_bf16 v[236:239], v[96:99], v[160:163], 0
    v_mfma_f32_16x16x32_bf16 v[176:179], v[48:51], v[112:115], 0
    v_mfma_f32_16x16x32_bf16 v[192:195], v[64:67], v[112:115], 0
    v_mfma_f32_16x16x32_bf16 v[208:211], v[80:83], v[112:115], 0
    v_mfma_f32_16x16x32_bf16 v[224:227], v[96:99], v[112:115], 0
    s_waitcnt vmcnt(8)
    v_mfma_f32_16x16x32_bf16 v[180:183], v[52:55], v[132:135], v[180:183]
    v_mfma_f32_16x16x32_bf16 v[196:199], v[68:71], v[132:135], v[196:199]
    v_mfma_f32_16x16x32_bf16 v[212:215], v[84:87], v[132:135], v[212:215]
    v_mfma_f32_16x16x32_bf16 v[228:231], v[100:103], v[132:135], v[228:231]
    v_mfma_f32_16x16x32_bf16 v[184:187], v[52:55], v[148:151], v[184:187]
    v_mfma_f32_16x16x32_bf16 v[200:203], v[68:71], v[148:151], v[200:203]
    v_mfma_f32_16x16x32_bf16 v[216:219], v[84:87], v[148:151], v[216:219]
    v_mfma_f32_16x16x32_bf16 v[232:235], v[100:103], v[148:151], v[232:235]
    v_mfma_f32_16x16x32_bf16 v[188:191], v[52:55], v[164:167], v[188:191]
    v_mfma_f32_16x16x32_bf16 v[204:207], v[68:71], v[164:167], v[204:207]
    v_mfma_f32_16x16x32_bf16 v[220:223], v[84:87], v[164:167], v[220:223]
    v_mfma_f32_16x16x32_bf16 v[236:239], v[100:103], v[164:167], v[236:239]
    v_mfma_f32_16x16x32_bf16 v[176:179], v[52:55], v[116:119], v[176:179]
    v_mfma_f32_16x16x32_bf16 v[192:195], v[68:71], v[116:119], v[192:195]
    v_mfma_f32_16x16x32_bf16 v[208:211], v[84:87], v[116:119], v[208:211]
    v_mfma_f32_16x16x32_bf16 v[224:227], v[100:103], v[116:119], v[224:227]
    s_waitcnt vmcnt(4)
    v_mfma_f32_16x16x32_bf16 v[180:183], v[56:59], v[136:139], v[180:183]
    v_mfma_f32_16x16x32_bf16 v[196:199], v[72:75], v[136:139], v[196:199]
    v_mfma_f32_16x16x32_bf16 v[212:215], v[88:91], v[136:139], v[212:215]
    v_mfma_f32_16x16x32_bf16 v[228:231], v[104:107], v[136:139], v[228:231]
    v_mfma_f32_16x16x32_bf16 v[184:187], v[56:59], v[152:155], v[184:187]
    v_mfma_f32_16x16x32_bf16 v[200:203], v[72:75], v[152:155], v[200:203]
    v_mfma_f32_16x16x32_bf16 v[216:219], v[88:91], v[152:155], v[216:219]
    v_mfma_f32_16x16x32_bf16 v[232:235], v[104:107], v[152:155], v[232:235]
    v_mfma_f32_16x16x32_bf16 v[188:191], v[56:59], v[168:171], v[188:191]
    v_mfma_f32_16x16x32_bf16 v[204:207], v[72:75], v[168:171], v[204:207]
    v_mfma_f32_16x16x32_bf16 v[220:223], v[88:91], v[168:171], v[220:223]
    v_mfma_f32_16x16x32_bf16 v[236:239], v[104:107], v[168:171], v[236:239]
    v_mfma_f32_16x16x32_bf16 v[176:179], v[56:59], v[120:123], v[176:179]
    v_mfma_f32_16x16x32_bf16 v[192:195], v[72:75], v[120:123], v[192:195]
    v_mfma_f32_16x16x32_bf16 v[208:211], v[88:91], v[120:123], v[208:211]
    v_mfma_f32_16x16x32_bf16 v[224:227], v[104:107], v[120:123], v[224:227]
    s_waitcnt vmcnt(0)
    v_mfma_f32_16x16x32_bf16 v[180:183], v[60:63], v[140:143], v[180:183]
    v_mfma_f32_16x16x32_bf16 v[196:199], v[76:79], v[140:143], v[196:199]
    v_mfma_f32_16x16x32_bf16 v[212:215], v[92:95], v[140:143], v[212:215]
    v_mfma_f32_16x16x32_bf16 v[228:231], v[108:111], v[140:143], v[228:231]
    v_mfma_f32_16x16x32_bf16 v[184:187], v[60:63], v[156:159], v[184:187]
    v_mfma_f32_16x16x32_bf16 v[200:203], v[76:79], v[156:159], v[200:203]
    v_mfma_f32_16x16x32_bf16 v[216:219], v[92:95], v[156:159], v[216:219]
    v_mfma_f32_16x16x32_bf16 v[232:235], v[108:111], v[156:159], v[232:235]
    v_mfma_f32_16x16x32_bf16 v[188:191], v[60:63], v[172:175], v[188:191]
    v_mfma_f32_16x16x32_bf16 v[204:207], v[76:79], v[172:175], v[204:207]
    v_mfma_f32_16x16x32_bf16 v[220:223], v[92:95], v[172:175], v[220:223]
    v_mfma_f32_16x16x32_bf16 v[236:239], v[108:111], v[172:175], v[236:239]
    v_mfma_f32_16x16x32_bf16 v[176:179], v[60:63], v[124:127], v[176:179]
    v_mfma_f32_16x16x32_bf16 v[192:195], v[76:79], v[124:127], v[192:195]
    v_mfma_f32_16x16x32_bf16 v[208:211], v[92:95], v[124:127], v[208:211]
    v_mfma_f32_16x16x32_bf16 v[224:227], v[108:111], v[124:127], v[224:227]
    ds_write_b128 v45, v[180:183] offset:0
    ds_write_b128 v45, v[196:199] offset:1024
    ds_write_b128 v45, v[212:215] offset:2048
    ds_write_b128 v45, v[228:231] offset:3072
    ds_write_b128 v46, v[184:187] offset:0
    ds_write_b128 v46, v[200:203] offset:1024
    ds_write_b128 v46, v[216:219] offset:2048
    ds_write_b128 v46, v[232:235] offset:3072
    ds_write_b128 v47, v[188:191] offset:0
    ds_write_b128 v47, v[204:207] offset:1024
    ds_write_b128 v47, v[220:223] offset:2048
    ds_write_b128 v47, v[236:239] offset:3072
    s_waitcnt lgkmcnt(0)
    s_barrier
    ds_read_b128 v[48:51], v31 offset:0
    ds_read_b128 v[52:55], v31 offset:1024
    ds_read_b128 v[56:59], v31 offset:2048
    ds_read_b128 v[60:63], v31 offset:3072
    ds_read_b128 v[64:67], v31 offset:4096
    ds_read_b128 v[68:71], v31 offset:5120
    ds_read_b128 v[72:75], v31 offset:6144
    ds_read_b128 v[76:79], v31 offset:7168
    ds_read_b128 v[80:83], v31 offset:8192
    ds_read_b128 v[84:87], v31 offset:9216
    ds_read_b128 v[88:91], v31 offset:10240
    ds_read_b128 v[92:95], v31 offset:11264
    s_waitcnt lgkmcnt(8)
    v_add_f32 v176, v176, v48
    v_add_f32 v177, v177, v49
    v_add_f32 v178, v178, v50
    v_add_f32 v179, v179, v51
    v_add_f32 v192, v192, v52
    v_add_f32 v193, v193, v53
    v_add_f32 v194, v194, v54
    v_add_f32 v195, v195, v55
    v_add_f32 v208, v208, v56
    v_add_f32 v209, v209, v57
    v_add_f32 v210, v210, v58
    v_add_f32 v211, v211, v59
    v_add_f32 v224, v224, v60
    v_add_f32 v225, v225, v61
    v_add_f32 v226, v226, v62
    v_add_f32 v227, v227, v63
    s_waitcnt lgkmcnt(4)
    v_add_f32 v176, v176, v64
    v_add_f32 v177, v177, v65
    v_add_f32 v178, v178, v66
    v_add_f32 v179, v179, v67
    v_add_f32 v192, v192, v68
    v_add_f32 v193, v193, v69
    v_add_f32 v194, v194, v70
    v_add_f32 v195, v195, v71
    v_add_f32 v208, v208, v72
    v_add_f32 v209, v209, v73
    v_add_f32 v210, v210, v74
    v_add_f32 v211, v211, v75
    v_add_f32 v224, v224, v76
    v_add_f32 v225, v225, v77
    v_add_f32 v226, v226, v78
    v_add_f32 v227, v227, v79
    s_waitcnt lgkmcnt(0)
    v_add_f32 v176, v176, v80
    v_add_f32 v177, v177, v81
    v_add_f32 v178, v178, v82
    v_add_f32 v179, v179, v83
    v_add_f32 v192, v192, v84
    v_add_f32 v193, v193, v85
    v_add_f32 v194, v194, v86
    v_add_f32 v195, v195, v87
    v_add_f32 v208, v208, v88
    v_add_f32 v209, v209, v89
    v_add_f32 v210, v210, v90
    v_add_f32 v211, v211, v91
    v_add_f32 v224, v224, v92
    v_add_f32 v225, v225, v93
    v_add_f32 v226, v226, v94
    v_add_f32 v227, v227, v95
    s_mov_b32 s46, 0xffff0000
    v_lshlrev_b32 v112, 16, v32
    v_and_b32 v113, s46, v32
    v_add_f32 v112, v112, v176
    v_add_f32 v113, v113, v177
    v_cvt_pk_bf16_f32 v32, v112, v113
    v_lshlrev_b32 v114, 16, v33
    v_and_b32 v115, s46, v33
    v_add_f32 v114, v114, v178
    v_add_f32 v115, v115, v179
    v_cvt_pk_bf16_f32 v33, v114, v115
    v_lshlrev_b32 v116, 16, v34
    v_and_b32 v117, s46, v34
    v_add_f32 v116, v116, v192
    v_add_f32 v117, v117, v193
    v_cvt_pk_bf16_f32 v34, v116, v117
    v_lshlrev_b32 v118, 16, v35
    v_and_b32 v119, s46, v35
    v_add_f32 v118, v118, v194
    v_add_f32 v119, v119, v195
    v_cvt_pk_bf16_f32 v35, v118, v119
    v_lshlrev_b32 v120, 16, v36
    v_and_b32 v121, s46, v36
    v_add_f32 v120, v120, v208
    v_add_f32 v121, v121, v209
    v_cvt_pk_bf16_f32 v36, v120, v121
    v_lshlrev_b32 v122, 16, v37
    v_and_b32 v123, s46, v37
    v_add_f32 v122, v122, v210
    v_add_f32 v123, v123, v211
    v_cvt_pk_bf16_f32 v37, v122, v123
    v_lshlrev_b32 v124, 16, v38
    v_and_b32 v125, s46, v38
    v_add_f32 v124, v124, v224
    v_add_f32 v125, v125, v225
    v_cvt_pk_bf16_f32 v38, v124, v125
    v_lshlrev_b32 v126, 16, v39
    v_and_b32 v127, s46, v39
    v_add_f32 v126, v126, v226
    v_add_f32 v127, v127, v227
    v_cvt_pk_bf16_f32 v39, v126, v127
    s_lshl_b32 s46, s62, 14
    s_lshl_b32 s47, s56, 11
    s_add_u32 s46, s46, s47
    s_add_u32 s46, s46, 2097152
    s_cmp_eq_u32 s101, 0
    s_cbranch_scc1 L_dsl5
    buffer_store_dwordx4 v[32:35], v7, s[32:35], s46 offen
    buffer_store_dwordx4 v[36:39], v7, s[32:35], s46 offen offset:1024
    s_branch L_djn5
L_dsl5:
    buffer_store_dwordx4 v[32:35], v7, s[32:35], s46 offen sc1
    buffer_store_dwordx4 v[36:39], v7, s[32:35], s46 offen offset:1024 sc1
L_djn5:
    v_add_f32 v132, v112, v113
    v_mul_f32 v133, v112, v112
    v_add_f32 v134, v114, v115
    v_mul_f32 v135, v113, v113
    v_fma_f32 v133, v114, v114, v133
    v_fma_f32 v135, v115, v115, v135
    v_add_f32 v132, v132, v116
    v_fma_f32 v133, v116, v116, v133
    v_add_f32 v134, v134, v117
    v_fma_f32 v135, v117, v117, v135
    v_add_f32 v132, v132, v118
    v_fma_f32 v133, v118, v118, v133
    v_add_f32 v134, v134, v119
    v_fma_f32 v135, v119, v119, v135
    v_add_f32 v132, v132, v120
    v_fma_f32 v133, v120, v120, v133
    v_add_f32 v134, v134, v121
    v_fma_f32 v135, v121, v121, v135
    v_add_f32 v132, v132, v122
    v_fma_f32 v133, v122, v122, v133
    v_add_f32 v134, v134, v123
    v_fma_f32 v135, v123, v123, v135
    v_add_f32 v132, v132, v124
    v_fma_f32 v133, v124, v124, v133
    v_add_f32 v134, v134, v125
    v_fma_f32 v135, v125, v125, v135
    v_add_f32 v132, v132, v126
    v_fma_f32 v133, v126, v126, v133
    v_add_f32 v134, v134, v127
    v_fma_f32 v135, v127, v127, v135
    v_add_f32 v132, v132, v134
    v_add_f32 v133, v133, v135
    v_mov_b32 v136, v132
    v_mov_b32 v137, v133
    s_nop 0
    v_permlane32_swap_b32 v132, v136
    v_permlane32_swap_b32 v133, v137
    v_add_f32 v132, v132, v136
    v_add_f32 v133, v133, v137
    v_mov_b32 v136, v132
    v_mov_b32 v137, v133
    s_nop 0
    v_permlane16_swap_b32 v132, v136
    v_permlane16_swap_b32 v133, v137
    v_add_f32 v132, v132, v136
    v_add_f32 v133, v133, v137
    s_lshl_b32 s46, s62, 10
    s_lshr_b32 s47, s56, 1
    s_lshl_b32 s47, s47, 8
    s_add_u32 s46, s46, s47
    s_and_b32 s47, s56, 1
    s_lshl_b32 s47, s47, 3
    s_add_u32 s46, s46, s47
    s_add_u32 s46, s46, 12582912
    s_mov_b64 exec, 0xffff
    s_cmp_eq_u32 s101, 0
    s_cbranch_scc1 L_dsl6
    buffer_store_dwordx2 v[132:133], v7, s[32:35], s46 offen
    s_branch L_djn6
L_dsl6:
    buffer_store_dwordx2 v[132:133], v7, s[32:35], s46 offen sc1
L_djn6:
    s_mov_b64 exec, -1
    s_waitcnt vmcnt(0)
    s_barrier
    s_mov_b64 exec, 1
    s_cmp_lg_u32 s44, 0
    s_cbranch_scc1 L_sg2
    v_mov_b32 v4, s99
    s_mov_b32 s64, 4096
    s_cmp_eq_u32 s101, 0
    s_cbranch_scc1 L_dsl7
    buffer_store_dword v4, v8, s[32:35], s64 offen
    s_branch L_djn7
L_dsl7:
    buffer_store_dword v4, v8, s[32:35], s64 offen sc1
L_djn7:
L_sg2:
    s_mov_b64 exec, -1
    s_lshl_b32 s65, s40, 3
    s_lshl_b32 s47, s44, 1
    s_add_u32 s65, s65, s47
    s_lshl_b32 s65, s65, 14
    s_add_u32 s65, s65, 2097152
    s_lshl_b32 s66, s44, 11
    s_mul_i32 s67, s44, 458752
    s_lshl_b32 s48, s56, 7
    s_add_u32 s67, s67, s48
    s_lshl_b32 s68, s44, 12
    s_add_u32 s48, s68, 49152
    v_lshrrev_b32 v4, 2, v2
    v_lshl_add_u32 v5, v3, 2, v4
    v_lshrrev_b32 v6, 1, v5
    v_and_b32 v6, 3, v6
    v_lshlrev_b32 v5, 7, v5
    v_lshl_add_u32 v5, v6, 5, v5
    v_and_b32 v6, 3, v1
    v_lshl_add_u32 v5, v6, 3, v5
    v_xor_b32 v40, 0, v5
    v_xor_b32 v41, 32, v5
    v_xor_b32 v42, 64, v5
    v_xor_b32 v43, 96, v5
    v_add_u32 v40, s48, v40
    v_add_u32 v41, s48, v41
    v_add_u32 v42, s48, v42
    v_add_u32 v43, s48, v43
    s_cmp_lg_u32 s42, 4
    s_cbranch_scc1 L_pollB2_ok
    s_mov_b32 s58, 0
    s_lshl_b32 s64, s40, 8
    s_add_u32 s64, s64, 13635584
    v_and_b32 v5, 15, v1
    v_lshlrev_b32 v5, 2, v5
L_pollB2:
    buffer_load_dword v4, v5, s[32:35], s64 offen sc1
    s_waitcnt vmcnt(0)
    v_cmp_ne_u32 vcc, s99, v4
    s_add_u32 s58, s58, 1
    s_cbranch_vccz L_pollB2_ok
    s_sleep 1
    s_cmp_lt_u32 s58, 0x8000
    s_cbranch_scc1 L_pollB2
L_pollB2_ok:
    s_setprio 3
    s_barrier
    s_add_u32 s7, s5, 0
    s_and_b32 s7, s7, 15
    s_lshl_b32 s7, s7, 10
    s_add_u32 s7, s7, s65
    s_add_u32 m0, s66, 0
    s_add_u32 s64, s7, 0
    buffer_load_dwordx4 v7, s[32:35], s64 offen sc1 lds
    s_add_u32 m0, s66, 1024
    s_add_u32 s64, s7, 16384
    buffer_load_dwordx4 v7, s[32:35], s64 offen sc1 lds
    s_add_u32 s7, s5, 1
    s_and_b32 s7, s7, 15
    s_lshl_b32 s7, s7, 10
    s_add_u32 s7, s7, s65
    s_add_u32 m0, s66, 8192
    s_add_u32 s64, s7, 0
    buffer_load_dwordx4 v7, s[32:35], s64 offen sc1 lds
    s_add_u32 m0, s66, 9216
    s_add_u32 s64, s7, 16384
    buffer_load_dwordx4 v7, s[32:35], s64 offen sc1 lds
    s_add_u32 s7, s5, 2
    s_and_b32 s7, s7, 15
    s_lshl_b32 s7, s7, 10
    s_add_u32 s7, s7, s65
    s_add_u32 m0, s66, 16384
    s_add_u32 s64, s7, 0
    buffer_load_dwordx4 v7, s[32:35], s64 offen sc1 lds
    s_add_u32 m0, s66, 17408
    s_add_u32 s64, s7, 16384
    buffer_load_dwordx4 v7, s[32:35], s64 offen sc1 lds
    s_add_u32 s7, s5, 3
    s_and_b32 s7, s7, 15
    s_lshl_b32 s7, s7, 10
    s_add_u32 s7, s7, s65
    s_add_u32 m0, s66, 24576
    s_add_u32 s64, s7, 0
    buffer_load_dwordx4 v7, s[32:35], s64 offen sc1 lds
    s_add_u32 m0, s66, 25600
    s_add_u32 s64, s7, 16384
    buffer_load_dwordx4 v7, s[32:35], s64 offen sc1 lds
    s_waitcnt vmcnt(4)
    s_barrier
    s_add_u32 s7, s5, 4
    s_and_b32 s7, s7, 15
    s_lshl_b32 s7, s7, 10
    s_add_u32 s7, s7, s65
    s_add_u32 m0, s66, 32768
    s_add_u32 s64, s7, 0
    buffer_load_dwordx4 v7, s[32:35], s64 offen sc1 lds
    s_add_u32 m0, s66, 33792
    s_add_u32 s64, s7, 16384
    buffer_load_dwordx4 v7, s[32:35], s64 offen sc1 lds
    s_add_u32 s7, s5, 5
    s_and_b32 s7, s7, 15
    s_lshl_b32 s7, s7, 10
    s_add_u32 s7, s7, s65
    s_add_u32 m0, s66, 40960
    s_add_u32 s64, s7, 0
    buffer_load_dwordx4 v7, s[32:35], s64 offen sc1 lds
    s_add_u32 m0, s66, 41984
    s_add_u32 s64, s7, 16384
    buffer_load_dwordx4 v7, s[32:35], s64 offen sc1 lds
    s_waitcnt vmcnt(4)
    s_barrier
    s_add_u32 s7, s5, 6
    s_and_b32 s7, s7, 15
    s_lshl_b32 s7, s7, 10
    s_add_u32 s7, s7, s65
    s_add_u32 m0, s66, 0
    s_add_u32 s64, s7, 0
    buffer_load_dwordx4 v7, s[32:35], s64 offen sc1 lds
    s_add_u32 m0, s66, 1024
    s_add_u32 s64, s7, 16384
    buffer_load_dwordx4 v7, s[32:35], s64 offen sc1 lds
    s_add_u32 s7, s5, 7
    s_and_b32 s7, s7, 15
    s_lshl_b32 s7, s7, 10
    s_add_u32 s7, s7, s65
    s_add_u32 m0, s66, 8192
    s_add_u32 s64, s7, 0
    buffer_load_dwordx4 v7, s[32:35], s64 offen sc1 lds
    s_add_u32 m0, s66, 9216
    s_add_u32 s64, s7, 16384
    buffer_load_dwordx4 v7, s[32:35], s64 offen sc1 lds
    s_waitcnt vmcnt(4)
    s_barrier
    s_add_u32 s7, s5, 8
    s_and_b32 s7, s7, 15
    s_lshl_b32 s7, s7, 10
    s_add_u32 s7, s7, s65
    s_add_u32 m0, s66, 16384
    s_add_u32 s64, s7, 0
    buffer_load_dwordx4 v7, s[32:35], s64 offen sc1 lds
    s_add_u32 m0, s66, 17408
    s_add_u32 s64, s7, 16384
    buffer_load_dwordx4 v7, s[32:35], s64 offen sc1 lds
    s_add_u32 s7, s5, 9
    s_and_b32 s7, s7, 15
    s_lshl_b32 s7, s7, 10
    s_add_u32 s7, s7, s65
    s_add_u32 m0, s66, 24576
    s_add_u32 s64, s7, 0
    buffer_load_dwordx4 v7, s[32:35], s64 offen sc1 lds
    s_add_u32 m0, s66, 25600
    s_add_u32 s64, s7, 16384
    buffer_load_dwordx4 v7, s[32:35], s64 offen sc1 lds
    s_add_u32 s7, s6, 1
    s_sub_u32 s46, s7, 14
    s_cmp_ge_u32 s7, 14
    s_cselect_b32 s7, s46, s7
    s_lshl_b32 s7, s7, 15
    s_add_u32 s7, s7, s67
    s_add_u32 m0, s68, 49152
    s_add_u32 s64, s7, 0
    buffer_load_dwordx4 v9, s[24:27], s64 offen lds
    s_add_u32 m0, s68, 50176
    s_add_u32 s64, s7, 8192
    buffer_load_dwordx4 v9, s[24:27], s64 offen lds
    s_add_u32 m0, s68, 51200
    s_add_u32 s64, s7, 16384
    buffer_load_dwordx4 v9, s[24:27], s64 offen lds
    s_add_u32 m0, s68, 52224
    s_add_u32 s64, s7, 24576
    buffer_load_dwordx4 v9, s[24:27], s64 offen lds
    s_waitcnt vmcnt(8)
    s_barrier
    s_add_u32 s7, s5, 10
    s_and_b32 s7, s7, 15
    s_lshl_b32 s7, s7, 10
    s_add_u32 s7, s7, s65
    s_add_u32 m0, s66, 32768
    s_add_u32 s64, s7, 0
    buffer_load_dwordx4 v7, s[32:35], s64 offen sc1 lds
    s_add_u32 m0, s66, 33792
    s_add_u32 s64, s7, 16384
    buffer_load_dwordx4 v7, s[32:35], s64 offen sc1 lds
    s_add_u32 s7, s5, 11
    s_and_b32 s7, s7, 15
    s_lshl_b32 s7, s7, 10
    s_add_u32 s7, s7, s65
    s_add_u32 m0, s66, 40960
    s_add_u32 s64, s7, 0
    buffer_load_dwordx4 v7, s[32:35], s64 offen sc1 lds
    s_add_u32 m0, s66, 41984
    s_add_u32 s64, s7, 16384
    buffer_load_dwordx4 v7, s[32:35], s64 offen sc1 lds
    s_add_u32 s7, s6, 3
    s_sub_u32 s46, s7, 14
    s_cmp_ge_u32 s7, 14
    s_cselect_b32 s7, s46, s7
    s_lshl_b32 s7, s7, 15
    s_add_u32 s7, s7, s67
    s_add_u32 m0, s68, 65536
    s_add_u32 s64, s7, 0
    buffer_load_dwordx4 v9, s[24:27], s64 offen lds
    s_add_u32 m0, s68, 66560
    s_add_u32 s64, s7, 8192
    buffer_load_dwordx4 v9, s[24:27], s64 offen lds
    s_add_u32 m0, s68, 67584
    s_add_u32 s64, s7, 16384
    buffer_load_dwordx4 v9, s[24:27], s64 offen lds
    s_add_u32 m0, s68, 68608
    s_add_u32 s64, s7, 24576
    buffer_load_dwordx4 v9, s[24:27], s64 offen lds
    s_waitcnt vmcnt(12)
    s_barrier
    s_add_u32 s7, s5, 12
    s_and_b32 s7, s7, 15
    s_lshl_b32 s7, s7, 10
    s_add_u32 s7, s7, s65
    s_add_u32 m0, s66, 0
    s_add_u32 s64, s7, 0
    buffer_load_dwordx4 v7, s[32:35], s64 offen sc1 lds
    s_add_u32 m0, s66, 1024
    s_add_u32 s64, s7, 16384
    buffer_load_dwordx4 v7, s[32:35], s64 offen sc1 lds
    s_add_u32 s7, s5, 13
    s_and_b32 s7, s7, 15
    s_lshl_b32 s7, s7, 10
    s_add_u32 s7, s7, s65
    s_add_u32 m0, s66, 8192
    s_add_u32 s64, s7, 0
    buffer_load_dwordx4 v7, s[32:35], s64 offen sc1 lds
    s_add_u32 m0, s66, 9216
    s_add_u32 s64, s7, 16384
    buffer_load_dwordx4 v7, s[32:35], s64 offen sc1 lds
    s_add_u32 s7, s6, 5
    s_sub_u32 s46, s7, 14
    s_cmp_ge_u32 s7, 14
    s_cselect_b32 s7, s46, s7
    s_lshl_b32 s7, s7, 15
    s_add_u32 s7, s7, s67
    s_add_u32 m0, s68, 81920
    s_add_u32 s64, s7, 0
    buffer_load_dwordx4 v9, s[24:27], s64 offen lds
    s_add_u32 m0, s68, 82944
    s_add_u32 s64, s7, 8192
    buffer_load_dwordx4 v9, s[24:27], s64 offen lds
    s_add_u32 m0, s68, 83968
    s_add_u32 s64, s7, 16384
    buffer_load_dwordx4 v9, s[24:27], s64 offen lds
    s_add_u32 m0, s68, 84992
    s_add_u32 s64, s7, 24576
    buffer_load_dwordx4 v9, s[24:27], s64 offen lds
    s_waitcnt vmcnt(16)
    ds_read_b64_tr_b16 v[48:49], v40 offset:0
    ds_read_b64_tr_b16 v[50:51], v40 offset:2048
    ds_read_b64_tr_b16 v[52:53], v41 offset:0
    ds_read_b64_tr_b16 v[54:55], v41 offset:2048
    ds_read_b64_tr_b16 v[56:57], v42 offset:0
    ds_read_b64_tr_b16 v[58:59], v42 offset:2048
    ds_read_b64_tr_b16 v[60:61], v43 offset:0
    ds_read_b64_tr_b16 v[62:63], v43 offset:2048
    s_waitcnt lgkmcnt(0)
    s_add_u32 s7, s6, 0
    s_sub_u32 s46, s7, 14
    s_cmp_ge_u32 s7, 14
    s_cselect_b32 s7, s46, s7
    s_lshl_b32 s7, s7, 15
    s_add_u32 s7, s7, s67
    s_add_u32 m0, s68, 49152
    s_add_u32 s64, s7, 0
    buffer_load_dwordx4 v9, s[24:27], s64 offen lds
    s_add_u32 m0, s68, 50176
    s_add_u32 s64, s7, 8192
    buffer_load_dwordx4 v9, s[24:27], s64 offen lds
    s_add_u32 m0, s68, 51200
    s_add_u32 s64, s7, 16384
    buffer_load_dwordx4 v9, s[24:27], s64 offen lds
    s_add_u32 m0, s68, 52224
    s_add_u32 s64, s7, 24576
    buffer_load_dwordx4 v9, s[24:27], s64 offen lds
    s_waitcnt vmcnt(16)
    s_barrier
    s_add_u32 s7, s5, 14
    s_and_b32 s7, s7, 15
    s_lshl_b32 s7, s7, 10
    s_add_u32 s7, s7, s65
    s_add_u32 m0, s66, 16384
    s_add_u32 s64, s7, 0
    buffer_load_dwordx4 v7, s[32:35], s64 offen sc1 lds
    s_add_u32 m0, s66, 17408
    s_add_u32 s64, s7, 16384
    buffer_load_dwordx4 v7, s[32:35], s64 offen sc1 lds
    s_add_u32 s7, s5, 15
    s_and_b32 s7, s7, 15
    s_lshl_b32 s7, s7, 10
    s_add_u32 s7, s7, s65
    s_add_u32 m0, s66, 24576
    s_add_u32 s64, s7, 0
    buffer_load_dwordx4 v7, s[32:35], s64 offen sc1 lds
    s_add_u32 m0, s66, 25600
    s_add_u32 s64, s7, 16384
    buffer_load_dwordx4 v7, s[32:35], s64 offen sc1 lds
    s_add_u32 s7, s6, 7
    s_sub_u32 s46, s7, 14
    s_cmp_ge_u32 s7, 14
    s_cselect_b32 s7, s46, s7
    s_lshl_b32 s7, s7, 15
    s_add_u32 s7, s7, s67
    s_add_u32 m0, s68, 98304
    s_add_u32 s64, s7, 0
    buffer_load_dwordx4 v9, s[24:27], s64 offen lds
    s_add_u32 m0, s68, 99328
    s_add_u32 s64, s7, 8192
    buffer_load_dwordx4 v9, s[24:27], s64 offen lds
    s_add_u32 m0, s68, 100352
    s_add_u32 s64, s7, 16384
    buffer_load_dwordx4 v9, s[24:27], s64 offen lds
    s_add_u32 m0, s68, 101376
    s_add_u32 s64, s7, 24576
    buffer_load_dwordx4 v9, s[24:27], s64 offen lds
    s_waitcnt vmcnt(20)
    ds_read_b64_tr_b16 v[64:65], v40 offset:16384
    ds_read_b64_tr_b16 v[66:67], v40 offset:18432
    ds_read_b64_tr_b16 v[68:69], v41 offset:16384
    ds_read_b64_tr_b16 v[70:71], v41 offset:18432
    ds_read_b64_tr_b16 v[72:73], v42 offset:16384
    ds_read_b64_tr_b16 v[74:75], v42 offset:18432
    ds_read_b64_tr_b16 v[76:77], v43 offset:16384
    ds_read_b64_tr_b16 v[78:79], v43 offset:18432
    s_waitcnt lgkmcnt(0)
    s_add_u32 s7, s6, 2
    s_sub_u32 s46, s7, 14
    s_cmp_ge_u32 s7, 14
    s_cselect_b32 s7, s46, s7
    s_lshl_b32 s7, s7, 15
    s_add_u32 s7, s7, s67
    s_add_u32 m0, s68, 65536
    s_add_u32 s64, s7, 0
    buffer_load_dwordx4 v9, s[24:27], s64 offen lds
    s_add_u32 m0, s68, 66560
    s_add_u32 s64, s7, 8192
    buffer_load_dwordx4 v9, s[24:27], s64 offen lds
    s_add_u32 m0, s68, 67584
    s_add_u32 s64, s7, 16384
    buffer_load_dwordx4 v9, s[24:27], s64 offen lds
    s_add_u32 m0, s68, 68608
    s_add_u32 s64, s7, 24576
    buffer_load_dwordx4 v9, s[24:27], s64 offen lds
    s_waitcnt vmcnt(20)
    s_barrier
    s_add_u32 s7, s6, 9
    s_sub_u32 s46, s7, 14
    s_cmp_ge_u32 s7, 14
    s_cselect_b32 s7, s46, s7
    s_lshl_b32 s7, s7, 15
    s_add_u32 s7, s7, s67
    s_add_u32 m0, s68, 114688
    s_add_u32 s64, s7, 0
    buffer_load_dwordx4 v9, s[24:27], s64 offen lds
    s_add_u32 m0, s68, 115712
    s_add_u32 s64, s7, 8192
    buffer_load_dwordx4 v9, s[24:27], s64 offen lds
    s_add_u32 m0, s68, 116736
    s_add_u32 s64, s7, 16384
    buffer_load_dwordx4 v9, s[24:27], s64 offen lds
    s_add_u32 m0, s68, 117760
    s_add_u32 s64, s7, 24576
    buffer_load_dwordx4 v9, s[24:27], s64 offen lds
    s_waitcnt vmcnt(20)
    ds_read_b64_tr_b16 v[80:81], v40 offset:32768
    ds_read_b64_tr_b16 v[82:83], v40 offset:34816
    ds_read_b64_tr_b16 v[84:85], v41 offset:32768
    ds_read_b64_tr_b16 v[86:87], v41 offset:34816
    ds_read_b64_tr_b16 v[88:89], v42 offset:32768
    ds_read_b64_tr_b16 v[90:91], v42 offset:34816
    ds_read_b64_tr_b16 v[92:93], v43 offset:32768
    ds_read_b64_tr_b16 v[94:95], v43 offset:34816
    s_waitcnt lgkmcnt(0)
    s_add_u32 s7, s6, 4
    s_sub_u32 s46, s7, 14
    s_cmp_ge_u32 s7, 14
    s_cselect_b32 s7, s46, s7
    s_lshl_b32 s7, s7, 15
    s_add_u32 s7, s7, s67
    s_add_u32 m0, s68, 81920
    s_add_u32 s64, s7, 0
    buffer_load_dwordx4 v9, s[24:27], s64 offen lds
    s_add_u32 m0, s68, 82944
    s_add_u32 s64, s7, 8192
    buffer_load_dwordx4 v9, s[24:27], s64 offen lds
    s_add_u32 m0, s68, 83968
    s_add_u32 s64, s7, 16384
    buffer_load_dwordx4 v9, s[24:27], s64 offen lds
    s_add_u32 m0, s68, 84992
    s_add_u32 s64, s7, 24576
    buffer_load_dwordx4 v9, s[24:27], s64 offen lds
    s_waitcnt vmcnt(16)
    s_barrier
    s_add_u32 s7, s6, 11
    s_sub_u32 s46, s7, 14
    s_cmp_ge_u32 s7, 14
    s_cselect_b32 s7, s46, s7
    s_lshl_b32 s7, s7, 15
    s_add_u32 s7, s7, s67
    s_add_u32 m0, s68, 131072
    s_add_u32 s64, s7, 0
    buffer_load_dwordx4 v9, s[24:27], s64 offen lds
    s_add_u32 m0, s68, 132096
    s_add_u32 s64, s7, 8192
    buffer_load_dwordx4 v9, s[24:27], s64 offen lds
    s_add_u32 m0, s68, 133120
    s_add_u32 s64, s7, 16384
    buffer_load_dwordx4 v9, s[24:27], s64 offen lds
    s_add_u32 m0, s68, 134144
    s_add_u32 s64, s7, 24576
    buffer_load_dwordx4 v9, s[24:27], s64 offen lds
    s_waitcnt vmcnt(16)
    ds_read_b64_tr_b16 v[96:97], v40 offset:49152
    ds_read_b64_tr_b16 v[98:99], v40 offset:51200
    ds_read_b64_tr_b16 v[100:101], v41 offset:49152
    ds_read_b64_tr_b16 v[102:103], v41 offset:51200
    ds_read_b64_tr_b16 v[104:105], v42 offset:49152
    ds_read_b64_tr_b16 v[106:107], v42 offset:51200
    ds_read_b64_tr_b16 v[108:109], v43 offset:49152
    ds_read_b64_tr_b16 v[110:111], v43 offset:51200
    s_waitcnt lgkmcnt(0)
    s_add_u32 s7, s6, 6
    s_sub_u32 s46, s7, 14
    s_cmp_ge_u32 s7, 14
    s_cselect_b32 s7, s46, s7
    s_lshl_b32 s7, s7, 15
    s_add_u32 s7, s7, s67
    s_add_u32 m0, s68, 98304
    s_add_u32 s64, s7, 0
    buffer_load_dwordx4 v9, s[24:27], s64 offen lds
    s_add_u32 m0, s68, 99328
    s_add_u32 s64, s7, 8192
    buffer_load_dwordx4 v9, s[24:27], s64 offen lds
    s_add_u32 m0, s68, 100352
    s_add_u32 s64, s7, 16384
    buffer_load_dwordx4 v9, s[24:27], s64 offen lds
    s_add_u32 m0, s68, 101376
    s_add_u32 s64, s7, 24576
    buffer_load_dwordx4 v9, s[24:27], s64 offen lds
    s_barrier
    s_add_u32 s7, s6, 13
    s_sub_u32 s46, s7, 14
    s_cmp_ge_u32 s7, 14
    s_cselect_b32 s7, s46, s7
    s_lshl_b32 s7, s7, 15
    s_add_u32 s7, s7, s67
    s_add_u32 m0, s68, 147456
    s_add_u32 s64, s7, 0
    buffer_load_dwordx4 v9, s[24:27], s64 offen lds
    s_add_u32 m0, s68, 148480
    s_add_u32 s64, s7, 8192
    buffer_load_dwordx4 v9, s[24:27], s64 offen lds
    s_add_u32 m0, s68, 149504
    s_add_u32 s64, s7, 16384
    buffer_load_dwordx4 v9, s[24:27], s64 offen lds
    s_add_u32 m0, s68, 150528
    s_add_u32 s64, s7, 24576
    buffer_load_dwordx4 v9, s[24:27], s64 offen lds
    s_waitcnt vmcnt(16)
    v_add_u32 v4, 0x10000, v40
    ds_read_b64_tr_b16 v[112:113], v4 offset:0
    ds_read_b64_tr_b16 v[114:115], v4 offset:2048
    v_add_u32 v4, 0x10000, v41
    ds_read_b64_tr_b16 v[116:117], v4 offset:0
    ds_read_b64_tr_b16 v[118:119], v4 offset:2048
    v_add_u32 v4, 0x10000, v42
    ds_read_b64_tr_b16 v[120:121], v4 offset:0
    ds_read_b64_tr_b16 v[122:123], v4 offset:2048
    v_add_u32 v4, 0x10000, v43
    ds_read_b64_tr_b16 v[124:125], v4 offset:0
    ds_read_b64_tr_b16 v[126:127], v4 offset:2048
    s_waitcnt lgkmcnt(0)
    s_add_u32 s7, s6, 8
    s_sub_u32 s46, s7, 14
    s_cmp_ge_u32 s7, 14
    s_cselect_b32 s7, s46, s7
    s_lshl_b32 s7, s7, 15
    s_add_u32 s7, s7, s67
    s_add_u32 m0, s68, 114688
    s_add_u32 s64, s7, 0
    buffer_load_dwordx4 v9, s[24:27], s64 offen lds
    s_add_u32 m0, s68, 115712
    s_add_u32 s64, s7, 8192
    buffer_load_dwordx4 v9, s[24:27], s64 offen lds
    s_add_u32 m0, s68, 116736
    s_add_u32 s64, s7, 16384
    buffer_load_dwordx4 v9, s[24:27], s64 offen lds
    s_add_u32 m0, s68, 117760
    s_add_u32 s64, s7, 24576
    buffer_load_dwordx4 v9, s[24:27], s64 offen lds
    s_waitcnt vmcnt(12)
    v_add_u32 v4, 0x10000, v40
    ds_read_b64_tr_b16 v[128:129], v4 offset:16384
    ds_read_b64_tr_b16 v[130:131], v4 offset:18432
    v_add_u32 v4, 0x10000, v41
    ds_read_b64_tr_b16 v[132:133], v4 offset:16384
    ds_read_b64_tr_b16 v[134:135], v4 offset:18432
    v_add_u32 v4, 0x10000, v42
    ds_read_b64_tr_b16 v[136:137], v4 offset:16384
    ds_read_b64_tr_b16 v[138:139], v4 offset:18432
    v_add_u32 v4, 0x10000, v43
    ds_read_b64_tr_b16 v[140:141], v4 offset:16384
    ds_read_b64_tr_b16 v[142:143], v4 offset:18432
    s_waitcnt lgkmcnt(0)
    s_add_u32 s7, s6, 10
    s_sub_u32 s46, s7, 14
    s_cmp_ge_u32 s7, 14
    s_cselect_b32 s7, s46, s7
    s_lshl_b32 s7, s7, 15
    s_add_u32 s7, s7, s67
    s_add_u32 m0, s68, 131072
    s_add_u32 s64, s7, 0
    buffer_load_dwordx4 v9, s[24:27], s64 offen lds
    s_add_u32 m0, s68, 132096
    s_add_u32 s64, s7, 8192
    buffer_load_dwordx4 v9, s[24:27], s64 offen lds
    s_add_u32 m0, s68, 133120
    s_add_u32 s64, s7, 16384
    buffer_load_dwordx4 v9, s[24:27], s64 offen lds
    s_add_u32 m0, s68, 134144
    s_add_u32 s64, s7, 24576
    buffer_load_dwordx4 v9, s[24:27], s64 offen lds
    s_waitcnt vmcnt(8)
    v_add_u32 v4, 0x10000, v40
    ds_read_b64_tr_b16 v[144:145], v4 offset:32768
    ds_read_b64_tr_b16 v[146:147], v4 offset:34816
    v_add_u32 v4, 0x10000, v41
    ds_read_b64_tr_b16 v[148:149], v4 offset:32768
    ds_read_b64_tr_b16 v[150:151], v4 offset:34816
    v_add_u32 v4, 0x10000, v42
    ds_read_b64_tr_b16 v[152:153], v4 offset:32768
    ds_read_b64_tr_b16 v[154:155], v4 offset:34816
    v_add_u32 v4, 0x10000, v43
    ds_read_b64_tr_b16 v[156:157], v4 offset:32768
    ds_read_b64_tr_b16 v[158:159], v4 offset:34816
    s_waitcnt lgkmcnt(0)
    s_add_u32 s7, s6, 12
    s_sub_u32 s46, s7, 14
    s_cmp_ge_u32 s7, 14
    s_cselect_b32 s7, s46, s7
    s_lshl_b32 s7, s7, 15
    s_add_u32 s7, s7, s67
    s_add_u32 m0, s68, 147456
    s_add_u32 s64, s7, 0
    buffer_load_dwordx4 v9, s[24:27], s64 offen lds
    s_add_u32 m0, s68, 148480
    s_add_u32 s64, s7, 8192
    buffer_load_dwordx4 v9, s[24:27], s64 offen lds
    s_add_u32 m0, s68, 149504
    s_add_u32 s64, s7, 16384
    buffer_load_dwordx4 v9, s[24:27], s64 offen lds
    s_add_u32 m0, s68, 150528
    s_add_u32 s64, s7, 24576
    buffer_load_dwordx4 v9, s[24:27], s64 offen lds
    s_add_u32 s51, s44, 1
    s_and_b32 s51, s51, 3
    s_mul_i32 s51, s51, 12288
    s_add_u32 s51, s51, 0
    v_add_u32 v45, s51, v7
    s_add_u32 s51, s44, 2
    s_and_b32 s51, s51, 3
    s_mul_i32 s51, s51, 12288
    s_add_u32 s51, s51, 4096
    v_add_u32 v46, s51, v7
    s_add_u32 s51, s44, 3
    s_and_b32 s51, s51, 3
    s_mul_i32 s51, s51, 12288
    s_add_u32 s51, s51, 8192
    v_add_u32 v47, s51, v7
    s_mul_i32 s51, s44, 12288
    s_add_u32 s51, s51, 0
    v_add_u32 v31, s51, v7
    s_lshl_b32 s46, s44, 12
    v_add_u32 v30, s46, v7
    s_setprio 0
    s_waitcnt vmcnt(0)
    s_barrier
    s_barrier
    ds_read_b128 v[240:243], v30 offset:0
    ds_read_b128 v[244:247], v30 offset:1024
    ds_read_b128 v[248:251], v30 offset:2048
    ds_read_b128 v[252:255], v30 offset:3072
    ds_read_b64_tr_b16 v[160:161], v40 offset:0
    ds_read_b64_tr_b16 v[162:163], v40 offset:2048
    ds_read_b64_tr_b16 v[164:165], v41 offset:0
    ds_read_b64_tr_b16 v[166:167], v41 offset:2048
    ds_read_b64_tr_b16 v[168:169], v42 offset:0
    ds_read_b64_tr_b16 v[170:171], v42 offset:2048
    ds_read_b64_tr_b16 v[172:173], v43 offset:0
    ds_read_b64_tr_b16 v[174:175], v43 offset:2048
    s_waitcnt lgkmcnt(0)
    s_barrier
    v_mfma_f32_16x16x32_bf16 v[180:183], v[160:163], v[244:247], 0
    ds_read_b128 v[14:17], v30 offset:16384
    v_mfma_f32_16x16x32_bf16 v[196:199], v[164:167], v[244:247], 0
    v_mfma_f32_16x16x32_bf16 v[212:215], v[168:171], v[244:247], 0
    v_mfma_f32_16x16x32_bf16 v[228:231], v[172:175], v[244:247], 0
    v_mfma_f32_16x16x32_bf16 v[184:187], v[160:163], v[248:251], 0
    ds_read_b128 v[18:21], v30 offset:17408
    v_mfma_f32_16x16x32_bf16 v[200:203], v[164:167], v[248:251], 0
    v_mfma_f32_16x16x32_bf16 v[216:219], v[168:171], v[248:251], 0
    v_mfma_f32_16x16x32_bf16 v[232:235], v[172:175], v[248:251], 0
    v_mfma_f32_16x16x32_bf16 v[188:191], v[160:163], v[252:255], 0
    ds_read_b128 v[22:25], v30 offset:18432
    v_mfma_f32_16x16x32_bf16 v[204:207], v[164:167], v[252:255], 0
    v_mfma_f32_16x16x32_bf16 v[220:223], v[168:171], v[252:255], 0
    v_mfma_f32_16x16x32_bf16 v[236:239], v[172:175], v[252:255], 0
    v_mfma_f32_16x16x32_bf16 v[176:179], v[160:163], v[240:243], 0
    ds_read_b128 v[26:29], v30 offset:19456
    v_mfma_f32_16x16x32_bf16 v[192:195], v[164:167], v[240:243], 0
    v_mfma_f32_16x16x32_bf16 v[208:211], v[168:171], v[240:243], 0
    v_mfma_f32_16x16x32_bf16 v[224:227], v[172:175], v[240:243], 0
    s_waitcnt lgkmcnt(0)
    s_barrier
    v_mfma_f32_16x16x32_bf16 v[180:183], v[48:51], v[18:21], v[180:183]
    ds_read_b128 v[240:243], v30 offset:32768
    v_mfma_f32_16x16x32_bf16 v[196:199], v[52:55], v[18:21], v[196:199]
    ds_read_b128 v[244:247], v30 offset:33792
    v_mfma_f32_16x16x32_bf16 v[212:215], v[56:59], v[18:21], v[212:215]
    ds_read_b128 v[248:251], v30 offset:34816
    v_mfma_f32_16x16x32_bf16 v[228:231], v[60:63], v[18:21], v[228:231]
    v_mfma_f32_16x16x32_bf16 v[184:187], v[48:51], v[22:25], v[184:187]
    ds_read_b128 v[252:255], v30 offset:35840
    v_mfma_f32_16x16x32_bf16 v[200:203], v[52:55], v[22:25], v[200:203]
    ds_read_b64_tr_b16 v[160:161], v40 offset:16384
    v_mfma_f32_16x16x32_bf16 v[216:219], v[56:59], v[22:25], v[216:219]
    ds_read_b64_tr_b16 v[162:163], v40 offset:18432
    v_mfma_f32_16x16x32_bf16 v[232:235], v[60:63], v[22:25], v[232:235]
    v_mfma_f32_16x16x32_bf16 v[188:191], v[48:51], v[26:29], v[188:191]
    ds_read_b64_tr_b16 v[164:165], v41 offset:16384
    v_mfma_f32_16x16x32_bf16 v[204:207], v[52:55], v[26:29], v[204:207]
    ds_read_b64_tr_b16 v[166:167], v41 offset:18432
    v_mfma_f32_16x16x32_bf16 v[220:223], v[56:59], v[26:29], v[220:223]
    ds_read_b64_tr_b16 v[168:169], v42 offset:16384
    v_mfma_f32_16x16x32_bf16 v[236:239], v[60:63], v[26:29], v[236:239]
    v_mfma_f32_16x16x32_bf16 v[176:179], v[48:51], v[14:17], v[176:179]
    ds_read_b64_tr_b16 v[170:171], v42 offset:18432
    v_mfma_f32_16x16x32_bf16 v[192:195], v[52:55], v[14:17], v[192:195]
    ds_read_b64_tr_b16 v[172:173], v43 offset:16384
    v_mfma_f32_16x16x32_bf16 v[208:211], v[56:59], v[14:17], v[208:211]
    ds_read_b64_tr_b16 v[174:175], v43 offset:18432
    v_mfma_f32_16x16x32_bf16 v[224:227], v[60:63], v[14:17], v[224:227]
    s_waitcnt lgkmcnt(0)
    s_barrier
    v_mfma_f32_16x16x32_bf16 v[180:183], v[160:163], v[244:247], v[180:183]
    ds_read_b128 v[14:17], v30 offset:0
    v_mfma_f32_16x16x32_bf16 v[196:199], v[164:167], v[244:247], v[196:199]
    v_mfma_f32_16x16x32_bf16 v[212:215], v[168:171], v[244:247], v[212:215]
    v_mfma_f32_16x16x32_bf16 v[228:231], v[172:175], v[244:247], v[228:231]
    v_mfma_f32_16x16x32_bf16 v[184:187], v[160:163], v[248:251], v[184:187]
    ds_read_b128 v[18:21], v30 offset:1024
    v_mfma_f32_16x16x32_bf16 v[200:203], v[164:167], v[248:251], v[200:203]
    v_mfma_f32_16x16x32_bf16 v[216:219], v[168:171], v[248:251], v[216:219]
    v_mfma_f32_16x16x32_bf16 v[232:235], v[172:175], v[248:251], v[232:235]
    v_mfma_f32_16x16x32_bf16 v[188:191], v[160:163], v[252:255], v[188:191]
    ds_read_b128 v[22:25], v30 offset:2048
    v_mfma_f32_16x16x32_bf16 v[204:207], v[164:167], v[252:255], v[204:207]
    v_mfma_f32_16x16x32_bf16 v[220:223], v[168:171], v[252:255], v[220:223]
    v_mfma_f32_16x16x32_bf16 v[236:239], v[172:175], v[252:255], v[236:239]
    v_mfma_f32_16x16x32_bf16 v[176:179], v[160:163], v[240:243], v[176:179]
    ds_read_b128 v[26:29], v30 offset:3072
    v_mfma_f32_16x16x32_bf16 v[192:195], v[164:167], v[240:243], v[192:195]
    v_mfma_f32_16x16x32_bf16 v[208:211], v[168:171], v[240:243], v[208:211]
    v_mfma_f32_16x16x32_bf16 v[224:227], v[172:175], v[240:243], v[224:227]
    s_waitcnt lgkmcnt(0)
    s_barrier
    v_mfma_f32_16x16x32_bf16 v[180:183], v[64:67], v[18:21], v[180:183]
    ds_read_b128 v[240:243], v30 offset:16384
    v_mfma_f32_16x16x32_bf16 v[196:199], v[68:71], v[18:21], v[196:199]
    ds_read_b128 v[244:247], v30 offset:17408
    v_mfma_f32_16x16x32_bf16 v[212:215], v[72:75], v[18:21], v[212:215]
    ds_read_b128 v[248:251], v30 offset:18432
    v_mfma_f32_16x16x32_bf16 v[228:231], v[76:79], v[18:21], v[228:231]
    v_mfma_f32_16x16x32_bf16 v[184:187], v[64:67], v[22:25], v[184:187]
    ds_read_b128 v[252:255], v30 offset:19456
    v_mfma_f32_16x16x32_bf16 v[200:203], v[68:71], v[22:25], v[200:203]
    ds_read_b64_tr_b16 v[160:161], v40 offset:32768
    v_mfma_f32_16x16x32_bf16 v[216:219], v[72:75], v[22:25], v[216:219]
    ds_read_b64_tr_b16 v[162:163], v40 offset:34816
    v_mfma_f32_16x16x32_bf16 v[232:235], v[76:79], v[22:25], v[232:235]
    v_mfma_f32_16x16x32_bf16 v[188:191], v[64:67], v[26:29], v[188:191]
    ds_read_b64_tr_b16 v[164:165], v41 offset:32768
    v_mfma_f32_16x16x32_bf16 v[204:207], v[68:71], v[26:29], v[204:207]
    ds_read_b64_tr_b16 v[166:167], v41 offset:34816
    v_mfma_f32_16x16x32_bf16 v[220:223], v[72:75], v[26:29], v[220:223]
    ds_read_b64_tr_b16 v[168:169], v42 offset:32768
    v_mfma_f32_16x16x32_bf16 v[236:239], v[76:79], v[26:29], v[236:239]
    v_mfma_f32_16x16x32_bf16 v[176:179], v[64:67], v[14:17], v[176:179]
    ds_read_b64_tr_b16 v[170:171], v42 offset:34816
    v_mfma_f32_16x16x32_bf16 v[192:195], v[68:71], v[14:17], v[192:195]
    ds_read_b64_tr_b16 v[172:173], v43 offset:32768
    v_mfma_f32_16x16x32_bf16 v[208:211], v[72:75], v[14:17], v[208:211]
    ds_read_b64_tr_b16 v[174:175], v43 offset:34816
    v_mfma_f32_16x16x32_bf16 v[224:227], v[76:79], v[14:17], v[224:227]
    s_waitcnt lgkmcnt(0)
    s_barrier
    v_mfma_f32_16x16x32_bf16 v[180:183], v[160:163], v[244:247], v[180:183]
    ds_read_b128 v[14:17], v30 offset:32768
    v_mfma_f32_16x16x32_bf16 v[196:199], v[164:167], v[244:247], v[196:199]
    v_mfma_f32_16x16x32_bf16 v[212:215], v[168:171], v[244:247], v[212:215]
    v_mfma_f32_16x16x32_bf16 v[228:231], v[172:175], v[244:247], v[228:231]
    v_mfma_f32_16x16x32_bf16 v[184:187], v[160:163], v[248:251], v[184:187]
    ds_read_b128 v[18:21], v30 offset:33792
    v_mfma_f32_16x16x32_bf16 v[200:203], v[164:167], v[248:251], v[200:203]
    v_mfma_f32_16x16x32_bf16 v[216:219], v[168:171], v[248:251], v[216:219]
    v_mfma_f32_16x16x32_bf16 v[232:235], v[172:175], v[248:251], v[232:235]
    v_mfma_f32_16x16x32_bf16 v[188:191], v[160:163], v[252:255], v[188:191]
    ds_read_b128 v[22:25], v30 offset:34816
    v_mfma_f32_16x16x32_bf16 v[204:207], v[164:167], v[252:255], v[204:207]
    v_mfma_f32_16x16x32_bf16 v[220:223], v[168:171], v[252:255], v[220:223]
    v_mfma_f32_16x16x32_bf16 v[236:239], v[172:175], v[252:255], v[236:239]
    v_mfma_f32_16x16x32_bf16 v[176:179], v[160:163], v[240:243], v[176:179]
    ds_read_b128 v[26:29], v30 offset:35840
    v_mfma_f32_16x16x32_bf16 v[192:195], v[164:167], v[240:243], v[192:195]
    v_mfma_f32_16x16x32_bf16 v[208:211], v[168:171], v[240:243], v[208:211]
    v_mfma_f32_16x16x32_bf16 v[224:227], v[172:175], v[240:243], v[224:227]
    s_waitcnt lgkmcnt(0)
    s_barrier
    v_mfma_f32_16x16x32_bf16 v[180:183], v[80:83], v[18:21], v[180:183]
    ds_read_b128 v[240:243], v30 offset:0
    v_mfma_f32_16x16x32_bf16 v[196:199], v[84:87], v[18:21], v[196:199]
    ds_read_b128 v[244:247], v30 offset:1024
    v_mfma_f32_16x16x32_bf16 v[212:215], v[88:91], v[18:21], v[212:215]
    ds_read_b128 v[248:251], v30 offset:2048
    v_mfma_f32_16x16x32_bf16 v[228:231], v[92:95], v[18:21], v[228:231]
    v_mfma_f32_16x16x32_bf16 v[184:187], v[80:83], v[22:25], v[184:187]
    ds_read_b128 v[252:255], v30 offset:3072
    v_mfma_f32_16x16x32_bf16 v[200:203], v[84:87], v[22:25], v[200:203]
    ds_read_b64_tr_b16 v[160:161], v40 offset:49152
    v_mfma_f32_16x16x32_bf16 v[216:219], v[88:91], v[22:25], v[216:219]
    ds_read_b64_tr_b16 v[162:163], v40 offset:51200
    v_mfma_f32_16x16x32_bf16 v[232:235], v[92:95], v[22:25], v[232:235]
    v_mfma_f32_16x16x32_bf16 v[188:191], v[80:83], v[26:29], v[188:191]
    ds_read_b64_tr_b16 v[164:165], v41 offset:49152
    v_mfma_f32_16x16x32_bf16 v[204:207], v[84:87], v[26:29], v[204:207]
    ds_read_b64_tr_b16 v[166:167], v41 offset:51200
    v_mfma_f32_16x16x32_bf16 v[220:223], v[88:91], v[26:29], v[220:223]
    ds_read_b64_tr_b16 v[168:169], v42 offset:49152
    v_mfma_f32_16x16x32_bf16 v[236:239], v[92:95], v[26:29], v[236:239]
    v_mfma_f32_16x16x32_bf16 v[176:179], v[80:83], v[14:17], v[176:179]
    ds_read_b64_tr_b16 v[170:171], v42 offset:51200
    v_mfma_f32_16x16x32_bf16 v[192:195], v[84:87], v[14:17], v[192:195]
    ds_read_b64_tr_b16 v[172:173], v43 offset:49152
    v_mfma_f32_16x16x32_bf16 v[208:211], v[88:91], v[14:17], v[208:211]
    ds_read_b64_tr_b16 v[174:175], v43 offset:51200
    v_mfma_f32_16x16x32_bf16 v[224:227], v[92:95], v[14:17], v[224:227]
    s_waitcnt lgkmcnt(0)
    s_barrier
    v_mfma_f32_16x16x32_bf16 v[180:183], v[160:163], v[244:247], v[180:183]
    ds_read_b128 v[14:17], v30 offset:16384
    v_mfma_f32_16x16x32_bf16 v[196:199], v[164:167], v[244:247], v[196:199]
    v_mfma_f32_16x16x32_bf16 v[212:215], v[168:171], v[244:247], v[212:215]
    v_mfma_f32_16x16x32_bf16 v[228:231], v[172:175], v[244:247], v[228:231]
    v_mfma_f32_16x16x32_bf16 v[184:187], v[160:163], v[248:251], v[184:187]
    ds_read_b128 v[18:21], v30 offset:17408
    v_mfma_f32_16x16x32_bf16 v[200:203], v[164:167], v[248:251], v[200:203]
    v_mfma_f32_16x16x32_bf16 v[216:219], v[168:171], v[248:251], v[216:219]
    v_mfma_f32_16x16x32_bf16 v[232:235], v[172:175], v[248:251], v[232:235]
    v_mfma_f32_16x16x32_bf16 v[188:191], v[160:163], v[252:255], v[188:191]
    ds_read_b128 v[22:25], v30 offset:18432
    v_mfma_f32_16x16x32_bf16 v[204:207], v[164:167], v[252:255], v[204:207]
    v_mfma_f32_16x16x32_bf16 v[220:223], v[168:171], v[252:255], v[220:223]
    v_mfma_f32_16x16x32_bf16 v[236:239], v[172:175], v[252:255], v[236:239]
    v_mfma_f32_16x16x32_bf16 v[176:179], v[160:163], v[240:243], v[176:179]
    ds_read_b128 v[26:29], v30 offset:19456
    v_mfma_f32_16x16x32_bf16 v[192:195], v[164:167], v[240:243], v[192:195]
    v_mfma_f32_16x16x32_bf16 v[208:211], v[168:171], v[240:243], v[208:211]
    v_mfma_f32_16x16x32_bf16 v[224:227], v[172:175], v[240:243], v[224:227]
    s_waitcnt lgkmcnt(0)
    s_barrier
    v_add_u32 v40, 0x10000, v40
    v_add_u32 v41, 0x10000, v41
    v_add_u32 v42, 0x10000, v42
    v_add_u32 v43, 0x10000, v43
    v_mfma_f32_16x16x32_bf16 v[180:183], v[96:99], v[18:21], v[180:183]
    ds_read_b128 v[240:243], v30 offset:32768
    v_mfma_f32_16x16x32_bf16 v[196:199], v[100:103], v[18:21], v[196:199]
    ds_read_b128 v[244:247], v30 offset:33792
    v_mfma_f32_16x16x32_bf16 v[212:215], v[104:107], v[18:21], v[212:215]
    ds_read_b128 v[248:251], v30 offset:34816
    v_mfma_f32_16x16x32_bf16 v[228:231], v[108:111], v[18:21], v[228:231]
    v_mfma_f32_16x16x32_bf16 v[184:187], v[96:99], v[22:25], v[184:187]
    ds_read_b128 v[252:255], v30 offset:35840
    v_mfma_f32_16x16x32_bf16 v[200:203], v[100:103], v[22:25], v[200:203]
    ds_read_b64_tr_b16 v[160:161], v40 offset:0
    v_mfma_f32_16x16x32_bf16 v[216:219], v[104:107], v[22:25], v[216:219]
    ds_read_b64_tr_b16 v[162:163], v40 offset:2048
    v_mfma_f32_16x16x32_bf16 v[232:235], v[108:111], v[22:25], v[232:235]
    v_mfma_f32_16x16x32_bf16 v[188:191], v[96:99], v[26:29], v[188:191]
    ds_read_b64_tr_b16 v[164:165], v41 offset:0
    v_mfma_f32_16x16x32_bf16 v[204:207], v[100:103], v[26:29], v[204:207]
    ds_read_b64_tr_b16 v[166:167], v41 offset:2048
    v_mfma_f32_16x16x32_bf16 v[220:223], v[104:107], v[26:29], v[220:223]
    ds_read_b64_tr_b16 v[168:169], v42 offset:0
    v_mfma_f32_16x16x32_bf16 v[236:239], v[108:111], v[26:29], v[236:239]
    v_mfma_f32_16x16x32_bf16 v[176:179], v[96:99], v[14:17], v[176:179]
    ds_read_b64_tr_b16 v[170:171], v42 offset:2048
    v_mfma_f32_16x16x32_bf16 v[192:195], v[100:103], v[14:17], v[192:195]
    ds_read_b64_tr_b16 v[172:173], v43 offset:0
    v_mfma_f32_16x16x32_bf16 v[208:211], v[104:107], v[14:17], v[208:211]
    ds_read_b64_tr_b16 v[174:175], v43 offset:2048
    v_mfma_f32_16x16x32_bf16 v[224:227], v[108:111], v[14:17], v[224:227]
    s_waitcnt lgkmcnt(0)
    s_barrier
    v_mfma_f32_16x16x32_bf16 v[180:183], v[160:163], v[244:247], v[180:183]
    ds_read_b128 v[14:17], v30 offset:0
    v_mfma_f32_16x16x32_bf16 v[196:199], v[164:167], v[244:247], v[196:199]
    v_mfma_f32_16x16x32_bf16 v[212:215], v[168:171], v[244:247], v[212:215]
    v_mfma_f32_16x16x32_bf16 v[228:231], v[172:175], v[244:247], v[228:231]
    v_mfma_f32_16x16x32_bf16 v[184:187], v[160:163], v[248:251], v[184:187]
    ds_read_b128 v[18:21], v30 offset:1024
    v_mfma_f32_16x16x32_bf16 v[200:203], v[164:167], v[248:251], v[200:203]
    v_mfma_f32_16x16x32_bf16 v[216:219], v[168:171], v[248:251], v[216:219]
    v_mfma_f32_16x16x32_bf16 v[232:235], v[172:175], v[248:251], v[232:235]
    v_mfma_f32_16x16x32_bf16 v[188:191], v[160:163], v[252:255], v[188:191]
    ds_read_b128 v[22:25], v30 offset:2048
    v_mfma_f32_16x16x32_bf16 v[204:207], v[164:167], v[252:255], v[204:207]
    v_mfma_f32_16x16x32_bf16 v[220:223], v[168:171], v[252:255], v[220:223]
    v_mfma_f32_16x16x32_bf16 v[236:239], v[172:175], v[252:255], v[236:239]
    v_mfma_f32_16x16x32_bf16 v[176:179], v[160:163], v[240:243], v[176:179]
    ds_read_b128 v[26:29], v30 offset:3072
    v_mfma_f32_16x16x32_bf16 v[192:195], v[164:167], v[240:243], v[192:195]
    v_mfma_f32_16x16x32_bf16 v[208:211], v[168:171], v[240:243], v[208:211]
    v_mfma_f32_16x16x32_bf16 v[224:227], v[172:175], v[240:243], v[224:227]
    s_waitcnt lgkmcnt(0)
    s_barrier
    v_mfma_f32_16x16x32_bf16 v[180:183], v[112:115], v[18:21], v[180:183]
    ds_read_b128 v[240:243], v30 offset:16384
    v_mfma_f32_16x16x32_bf16 v[196:199], v[116:119], v[18:21], v[196:199]
    ds_read_b128 v[244:247], v30 offset:17408
    v_mfma_f32_16x16x32_bf16 v[212:215], v[120:123], v[18:21], v[212:215]
    ds_read_b128 v[248:251], v30 offset:18432
    v_mfma_f32_16x16x32_bf16 v[228:231], v[124:127], v[18:21], v[228:231]
    v_mfma_f32_16x16x32_bf16 v[184:187], v[112:115], v[22:25], v[184:187]
    ds_read_b128 v[252:255], v30 offset:19456
    v_mfma_f32_16x16x32_bf16 v[200:203], v[116:119], v[22:25], v[200:203]
    ds_read_b64_tr_b16 v[160:161], v40 offset:16384
    v_mfma_f32_16x16x32_bf16 v[216:219], v[120:123], v[22:25], v[216:219]
    ds_read_b64_tr_b16 v[162:163], v40 offset:18432
    v_mfma_f32_16x16x32_bf16 v[232:235], v[124:127], v[22:25], v[232:235]
    v_mfma_f32_16x16x32_bf16 v[188:191], v[112:115], v[26:29], v[188:191]
    ds_read_b64_tr_b16 v[164:165], v41 offset:16384
    v_mfma_f32_16x16x32_bf16 v[204:207], v[116:119], v[26:29], v[204:207]
    ds_read_b64_tr_b16 v[166:167], v41 offset:18432
    v_mfma_f32_16x16x32_bf16 v[220:223], v[120:123], v[26:29], v[220:223]
    ds_read_b64_tr_b16 v[168:169], v42 offset:16384
    v_mfma_f32_16x16x32_bf16 v[236:239], v[124:127], v[26:29], v[236:239]
    v_mfma_f32_16x16x32_bf16 v[176:179], v[112:115], v[14:17], v[176:179]
    ds_read_b64_tr_b16 v[170:171], v42 offset:18432
    v_mfma_f32_16x16x32_bf16 v[192:195], v[116:119], v[14:17], v[192:195]
    ds_read_b64_tr_b16 v[172:173], v43 offset:16384
    v_mfma_f32_16x16x32_bf16 v[208:211], v[120:123], v[14:17], v[208:211]
    ds_read_b64_tr_b16 v[174:175], v43 offset:18432
    v_mfma_f32_16x16x32_bf16 v[224:227], v[124:127], v[14:17], v[224:227]
    s_waitcnt lgkmcnt(0)
    s_barrier
    v_mfma_f32_16x16x32_bf16 v[180:183], v[160:163], v[244:247], v[180:183]
    ds_read_b128 v[14:17], v30 offset:32768
    v_mfma_f32_16x16x32_bf16 v[196:199], v[164:167], v[244:247], v[196:199]
    v_mfma_f32_16x16x32_bf16 v[212:215], v[168:171], v[244:247], v[212:215]
    v_mfma_f32_16x16x32_bf16 v[228:231], v[172:175], v[244:247], v[228:231]
    v_mfma_f32_16x16x32_bf16 v[184:187], v[160:163], v[248:251], v[184:187]
    ds_read_b128 v[18:21], v30 offset:33792
    v_mfma_f32_16x16x32_bf16 v[200:203], v[164:167], v[248:251], v[200:203]
    v_mfma_f32_16x16x32_bf16 v[216:219], v[168:171], v[248:251], v[216:219]
    v_mfma_f32_16x16x32_bf16 v[232:235], v[172:175], v[248:251], v[232:235]
    v_mfma_f32_16x16x32_bf16 v[188:191], v[160:163], v[252:255], v[188:191]
    ds_read_b128 v[22:25], v30 offset:34816
    v_mfma_f32_16x16x32_bf16 v[204:207], v[164:167], v[252:255], v[204:207]
    v_mfma_f32_16x16x32_bf16 v[220:223], v[168:171], v[252:255], v[220:223]
    v_mfma_f32_16x16x32_bf16 v[236:239], v[172:175], v[252:255], v[236:239]
    v_mfma_f32_16x16x32_bf16 v[176:179], v[160:163], v[240:243], v[176:179]
    ds_read_b128 v[26:29], v30 offset:35840
    v_mfma_f32_16x16x32_bf16 v[192:195], v[164:167], v[240:243], v[192:195]
    v_mfma_f32_16x16x32_bf16 v[208:211], v[168:171], v[240:243], v[208:211]
    v_mfma_f32_16x16x32_bf16 v[224:227], v[172:175], v[240:243], v[224:227]
    s_waitcnt lgkmcnt(0)
    s_barrier
    v_mfma_f32_16x16x32_bf16 v[180:183], v[128:131], v[18:21], v[180:183]
    ds_read_b128 v[240:243], v30 offset:0
    v_mfma_f32_16x16x32_bf16 v[196:199], v[132:135], v[18:21], v[196:199]
    ds_read_b128 v[244:247], v30 offset:1024
    v_mfma_f32_16x16x32_bf16 v[212:215], v[136:139], v[18:21], v[212:215]
    ds_read_b128 v[248:251], v30 offset:2048
    v_mfma_f32_16x16x32_bf16 v[228:231], v[140:143], v[18:21], v[228:231]
    v_mfma_f32_16x16x32_bf16 v[184:187], v[128:131], v[22:25], v[184:187]
    ds_read_b128 v[252:255], v30 offset:3072
    v_mfma_f32_16x16x32_bf16 v[200:203], v[132:135], v[22:25], v[200:203]
    ds_read_b64_tr_b16 v[160:161], v40 offset:32768
    v_mfma_f32_16x16x32_bf16 v[216:219], v[136:139], v[22:25], v[216:219]
    ds_read_b64_tr_b16 v[162:163], v40 offset:34816
    v_mfma_f32_16x16x32_bf16 v[232:235], v[140:143], v[22:25], v[232:235]
    v_mfma_f32_16x16x32_bf16 v[188:191], v[128:131], v[26:29], v[188:191]
    ds_read_b64_tr_b16 v[164:165], v41 offset:32768
    v_mfma_f32_16x16x32_bf16 v[204:207], v[132:135], v[26:29], v[204:207]
    ds_read_b64_tr_b16 v[166:167], v41 offset:34816
    v_mfma_f32_16x16x32_bf16 v[220:223], v[136:139], v[26:29], v[220:223]
    ds_read_b64_tr_b16 v[168:169], v42 offset:32768
    v_mfma_f32_16x16x32_bf16 v[236:239], v[140:143], v[26:29], v[236:239]
    v_mfma_f32_16x16x32_bf16 v[176:179], v[128:131], v[14:17], v[176:179]
    ds_read_b64_tr_b16 v[170:171], v42 offset:34816
    v_mfma_f32_16x16x32_bf16 v[192:195], v[132:135], v[14:17], v[192:195]
    ds_read_b64_tr_b16 v[172:173], v43 offset:32768
    v_mfma_f32_16x16x32_bf16 v[208:211], v[136:139], v[14:17], v[208:211]
    ds_read_b64_tr_b16 v[174:175], v43 offset:34816
    v_mfma_f32_16x16x32_bf16 v[224:227], v[140:143], v[14:17], v[224:227]
    s_waitcnt lgkmcnt(0)
    s_barrier
    v_mfma_f32_16x16x32_bf16 v[180:183], v[160:163], v[244:247], v[180:183]
    ds_read_b128 v[14:17], v30 offset:16384
    v_mfma_f32_16x16x32_bf16 v[196:199], v[164:167], v[244:247], v[196:199]
    v_mfma_f32_16x16x32_bf16 v[212:215], v[168:171], v[244:247], v[212:215]
    v_mfma_f32_16x16x32_bf16 v[228:231], v[172:175], v[244:247], v[228:231]
    v_mfma_f32_16x16x32_bf16 v[184:187], v[160:163], v[248:251], v[184:187]
    ds_read_b128 v[18:21], v30 offset:17408
    v_mfma_f32_16x16x32_bf16 v[200:203], v[164:167], v[248:251], v[200:203]
    v_mfma_f32_16x16x32_bf16 v[216:219], v[168:171], v[248:251], v[216:219]
    v_mfma_f32_16x16x32_bf16 v[232:235], v[172:175], v[248:251], v[232:235]
    v_mfma_f32_16x16x32_bf16 v[188:191], v[160:163], v[252:255], v[188:191]
    ds_read_b128 v[22:25], v30 offset:18432
    v_mfma_f32_16x16x32_bf16 v[204:207], v[164:167], v[252:255], v[204:207]
    v_mfma_f32_16x16x32_bf16 v[220:223], v[168:171], v[252:255], v[220:223]
    v_mfma_f32_16x16x32_bf16 v[236:239], v[172:175], v[252:255], v[236:239]
    v_mfma_f32_16x16x32_bf16 v[176:179], v[160:163], v[240:243], v[176:179]
    ds_read_b128 v[26:29], v30 offset:19456
    v_mfma_f32_16x16x32_bf16 v[192:195], v[164:167], v[240:243], v[192:195]
    v_mfma_f32_16x16x32_bf16 v[208:211], v[168:171], v[240:243], v[208:211]
    v_mfma_f32_16x16x32_bf16 v[224:227], v[172:175], v[240:243], v[224:227]
    s_waitcnt lgkmcnt(0)
    v_mfma_f32_16x16x32_bf16 v[180:183], v[144:147], v[18:21], v[180:183]
    v_mfma_f32_16x16x32_bf16 v[196:199], v[148:151], v[18:21], v[196:199]
    v_mfma_f32_16x16x32_bf16 v[212:215], v[152:155], v[18:21], v[212:215]
    v_mfma_f32_16x16x32_bf16 v[228:231], v[156:159], v[18:21], v[228:231]
    v_mfma_f32_16x16x32_bf16 v[184:187], v[144:147], v[22:25], v[184:187]
    v_mfma_f32_16x16x32_bf16 v[200:203], v[148:151], v[22:25], v[200:203]
    v_mfma_f32_16x16x32_bf16 v[216:219], v[152:155], v[22:25], v[216:219]
    v_mfma_f32_16x16x32_bf16 v[232:235], v[156:159], v[22:25], v[232:235]
    v_mfma_f32_16x16x32_bf16 v[188:191], v[144:147], v[26:29], v[188:191]
    v_mfma_f32_16x16x32_bf16 v[204:207], v[148:151], v[26:29], v[204:207]
    v_mfma_f32_16x16x32_bf16 v[220:223], v[152:155], v[26:29], v[220:223]
    v_mfma_f32_16x16x32_bf16 v[236:239], v[156:159], v[26:29], v[236:239]
    v_mfma_f32_16x16x32_bf16 v[176:179], v[144:147], v[14:17], v[176:179]
    v_mfma_f32_16x16x32_bf16 v[192:195], v[148:151], v[14:17], v[192:195]
    v_mfma_f32_16x16x32_bf16 v[208:211], v[152:155], v[14:17], v[208:211]
    v_mfma_f32_16x16x32_bf16 v[224:227], v[156:159], v[14:17], v[224:227]
    s_barrier
    ds_write_b128 v45, v[180:183] offset:0
    ds_write_b128 v45, v[196:199] offset:1024
    ds_write_b128 v45, v[212:215] offset:2048
    ds_write_b128 v45, v[228:231] offset:3072
    ds_write_b128 v46, v[184:187] offset:0
    ds_write_b128 v46, v[200:203] offset:1024
    ds_write_b128 v46, v[216:219] offset:2048
    ds_write_b128 v46, v[232:235] offset:3072
    ds_write_b128 v47, v[188:191] offset:0
    ds_write_b128 v47, v[204:207] offset:1024
    ds_write_b128 v47, v[220:223] offset:2048
    ds_write_b128 v47, v[236:239] offset:3072
    s_waitcnt lgkmcnt(0)
    s_barrier
    ds_read_b128 v[48:51], v31 offset:0
    ds_read_b128 v[52:55], v31 offset:1024
    ds_read_b128 v[56:59], v31 offset:2048
    ds_read_b128 v[60:63], v31 offset:3072
    ds_read_b128 v[64:67], v31 offset:4096
    ds_read_b128 v[68:71], v31 offset:5120
    ds_read_b128 v[72:75], v31 offset:6144
    ds_read_b128 v[76:79], v31 offset:7168
    ds_read_b128 v[80:83], v31 offset:8192
    ds_read_b128 v[84:87], v31 offset:9216
    ds_read_b128 v[88:91], v31 offset:10240
    ds_read_b128 v[92:95], v31 offset:11264
    s_waitcnt lgkmcnt(8)
    v_add_f32 v176, v176, v48
    v_add_f32 v177, v177, v49
    v_add_f32 v178, v178, v50
    v_add_f32 v179, v179, v51
    v_add_f32 v192, v192, v52
    v_add_f32 v193, v193, v53
    v_add_f32 v194, v194, v54
    v_add_f32 v195, v195, v55
    v_add_f32 v208, v208, v56
    v_add_f32 v209, v209, v57
    v_add_f32 v210, v210, v58
    v_add_f32 v211, v211, v59
    v_add_f32 v224, v224, v60
    v_add_f32 v225, v225, v61
    v_add_f32 v226, v226, v62
    v_add_f32 v227, v227, v63
    s_waitcnt lgkmcnt(4)
    v_add_f32 v176, v176, v64
    v_add_f32 v177, v177, v65
    v_add_f32 v178, v178, v66
    v_add_f32 v179, v179, v67
    v_add_f32 v192, v192, v68
    v_add_f32 v193, v193, v69
    v_add_f32 v194, v194, v70
    v_add_f32 v195, v195, v71
    v_add_f32 v208, v208, v72
    v_add_f32 v209, v209, v73
    v_add_f32 v210, v210, v74
    v_add_f32 v211, v211, v75
    v_add_f32 v224, v224, v76
    v_add_f32 v225, v225, v77
    v_add_f32 v226, v226, v78
    v_add_f32 v227, v227, v79
    s_waitcnt lgkmcnt(0)
    v_add_f32 v176, v176, v80
    v_add_f32 v177, v177, v81
    v_add_f32 v178, v178, v82
    v_add_f32 v179, v179, v83
    v_add_f32 v192, v192, v84
    v_add_f32 v193, v193, v85
    v_add_f32 v194, v194, v86
    v_add_f32 v195, v195, v87
    v_add_f32 v208, v208, v88
    v_add_f32 v209, v209, v89
    v_add_f32 v210, v210, v90
    v_add_f32 v211, v211, v91
    v_add_f32 v224, v224, v92
    v_add_f32 v225, v225, v93
    v_add_f32 v226, v226, v94
    v_add_f32 v227, v227, v95
    s_mov_b32 s46, 0xffff0000
    v_lshlrev_b32 v112, 16, v32
    v_and_b32 v113, s46, v32
    v_add_f32 v112, v112, v176
    v_add_f32 v113, v113, v177
    v_cvt_pk_bf16_f32 v32, v112, v113
    v_lshlrev_b32 v114, 16, v33
    v_and_b32 v115, s46, v33
    v_add_f32 v114, v114, v178
    v_add_f32 v115, v115, v179
    v_cvt_pk_bf16_f32 v33, v114, v115
    v_lshlrev_b32 v116, 16, v34
    v_and_b32 v117, s46, v34
    v_add_f32 v116, v116, v192
    v_add_f32 v117, v117, v193
    v_cvt_pk_bf16_f32 v34, v116, v117
    v_lshlrev_b32 v118, 16, v35
    v_and_b32 v119, s46, v35
    v_add_f32 v118, v118, v194
    v_add_f32 v119, v119, v195
    v_cvt_pk_bf16_f32 v35, v118, v119
    v_lshlrev_b32 v120, 16, v36
    v_and_b32 v121, s46, v36
    v_add_f32 v120, v120, v208
    v_add_f32 v121, v121, v209
    v_cvt_pk_bf16_f32 v36, v120, v121
    v_lshlrev_b32 v122, 16, v37
    v_and_b32 v123, s46, v37
    v_add_f32 v122, v122, v210
    v_add_f32 v123, v123, v211
    v_cvt_pk_bf16_f32 v37, v122, v123
    v_lshlrev_b32 v124, 16, v38
    v_and_b32 v125, s46, v38
    v_add_f32 v124, v124, v224
    v_add_f32 v125, v125, v225
    v_cvt_pk_bf16_f32 v38, v124, v125
    v_lshlrev_b32 v126, 16, v39
    v_and_b32 v127, s46, v39
    v_add_f32 v126, v126, v226
    v_add_f32 v127, v127, v227
    v_cvt_pk_bf16_f32 v39, v126, v127
    v_lshlrev_b32 v44, 10, v2
    v_lshl_add_u32 v44, v3, 3, v44
    buffer_store_dwordx2 v[32:33], v44, s[28:31], s63 offen offset:0
    buffer_store_dwordx2 v[34:35], v44, s[28:31], s63 offen offset:32
    buffer_store_dwordx2 v[36:37], v44, s[28:31], s63 offen offset:64
    buffer_store_dwordx2 v[38:39], v44, s[28:31], s63 offen offset:96
    s_endpgm
L_done:
    s_endpgm
.section .rodata,"a"
.p2align 6
.amdhsa_kernel sequential_preLN__sliding_local_dilated__dense_activation_silu__prompt_kernel
  .amdhsa_next_free_vgpr 256
  .amdhsa_next_free_sgpr 102
  .amdhsa_accum_offset 256
  .amdhsa_group_segment_fixed_size 0
  .amdhsa_kernarg_size 72
  .amdhsa_user_sgpr_count 2
  .amdhsa_user_sgpr_kernarg_segment_ptr 1
  .amdhsa_system_sgpr_workgroup_id_x 1
.end_amdhsa_kernel
```
